```python
import torch

def _softmax(x, axis=-1):
    return torch.softmax(x, dim=axis)
def _gelu(x):
    return torch.nn.functional.gelu(x, approximate="tanh")
def _silu(x):
    return torch.nn.functional.silu(x)
def _sigmoid(x):
    return torch.sigmoid(x)
def _layernorm(x, axis=-1, eps=1e-5):
    m = x.mean(dim=axis, keepdim=True)
    v = x.var(dim=axis, keepdim=True, unbiased=False)
    return (x - m) / torch.sqrt(v + eps)
def _scatter_add(tgt, idx, src, axis=0):
    return tgt.clone().index_add_(axis, idx, src)
def _segment_sum(src, seg, n):
    out = torch.zeros((n,) + src.shape[1:], dtype=src.dtype)
    return out.index_add_(0, seg, src)
def _pad(x, pw):
    flat = tuple(v for pair in reversed(pw) for v in pair)
    return torch.nn.functional.pad(x, flat)

kernel_name = 'parallel_sum__grouped_kv_mqa__glu_gated_swiglu__prompt'

def setup_inputs():

    _w = (lambda a: (lambda t: t.to(torch.bfloat16) if t.is_floating_point() else t)(torch.as_tensor(a)))
    def _A_setup():
        B, S, D, H = 1, 2048, 640, 32
        Dh = D // H
        return {
            "x": _w((lambda *s: torch.randn(*s, dtype=torch.bfloat16) * 0.05)(B, S, D)),
            "wq": _w((lambda *s: torch.randn(*s, dtype=torch.bfloat16) * 0.05)(D, H * Dh)),
            "wk": _w((lambda *s: torch.randn(*s, dtype=torch.bfloat16) * 0.05)(D, Dh)),
            "wv": _w((lambda *s: torch.randn(*s, dtype=torch.bfloat16) * 0.05)(D, Dh)),
            "wo": _w((lambda *s: torch.randn(*s, dtype=torch.bfloat16) * 0.05)(H * Dh, D)),
        }
    _A_in = _A_setup()

    def _B_setup():
        B, S, D, F = 1, 2048, 640, 1536
        return {
            "x": _w((lambda *s: torch.randn(*s, dtype=torch.bfloat16) * 0.05)(B, S, D)),
            "w1": _w((lambda *s: torch.randn(*s, dtype=torch.bfloat16) * 0.4)(D, F) * (2.0 / D) ** 0.5),
            "w3": _w((lambda *s: torch.randn(*s, dtype=torch.bfloat16) * 0.4)(D, F) * (2.0 / D) ** 0.5),
            "w2": _w((lambda *s: torch.randn(*s, dtype=torch.bfloat16) * 0.4)(F, D) * (2.0 / F) ** 0.5),
        }
    _B_in = _B_setup()

    return {
        "A_x": _A_in["x"],
        "A_wq": _A_in["wq"],
        "A_wk": _A_in["wk"],
        "A_wv": _A_in["wv"],
        "A_wo": _A_in["wo"],
        "B_x": _B_in["x"],
        "B_w1": _B_in["w1"],
        "B_w3": _B_in["w3"],
        "B_w2": _B_in["w2"],
    }

def reference(A_x, A_wq, A_wk, A_wv, A_wo, B_x, B_w1, B_w3, B_w2):
    def _A_ref(x, wq, wk, wv, wo):
        B, S, D = x.shape
        H = 32
        Dh = D // H
        q = (lambda x, *d: x.permute(*d))((x @ wq).reshape(B, S, H, Dh), 0, 2, 1, 3)
        k = x @ wk
        v = x @ wv
        scores = torch.einsum("bhqd,bkd->bhqk", q, k) * (Dh ** -0.5)
        p = _softmax(scores, axis=-1)
        o = torch.einsum("bhqk,bkd->bhqd", p, v)
        return (lambda x, *d: x.permute(*d))(o, 0, 2, 1, 3).reshape(B, S, H * Dh) @ wo

    def _B_ref(x, w1, w3, w2):
        gate = torch.einsum("bsd,df->bsf", x, w1)
        up = torch.einsum("bsd,df->bsf", x, w3)
        h = _silu(gate) * up
        out = torch.einsum("bsf,fd->bsd", h, w2)
        return out

    x = A_x
    xn = _layernorm(x, axis=-1)
    return x + _A_ref(xn, A_wq, A_wk, A_wv, A_wo) + _B_ref(xn, B_w1, B_w3, B_w2)
```

```asm
; @launch kernel=qkv_kernel grid=(256,1,1) block=(256,1,1) lds=155648
; @launch kernel=main_kernel grid=(512,1,1) block=(256,1,1) lds=73728
.amdgcn_target "amdgcn-amd-amdhsa--gfx950"
.text
.globl qkv_kernel
.p2align 8
.type qkv_kernel,@function
qkv_kernel:
    s_cmp_ge_u32 s2, 256
    s_cbranch_scc1 qkv_end
    s_load_dwordx4 s[4:7], s[0:1], 0
    s_load_dwordx4 s[8:11], s[0:1], 16
    s_load_dwordx2 s[12:13], s[0:1], 88
    s_load_dwordx4 s[56:59], s[0:1], 48
    v_and_b32 v1, 63, v0
    v_lshrrev_b32 v92, 6, v0
    s_nop 0
    v_readfirstlane_b32 s32, v92
    v_and_b32 v2, 31, v0
    v_bfe_u32 v3, v0, 5, 1
    s_and_b32 s3, s2, 7
    s_lshl_b32 s3, s3, 2
    s_bfe_u32 s36, s2, 0x20003
    s_add_u32 s33, s3, s36
    s_lshr_b32 s34, s2, 5
    v_mul_u32_u24 v92, 49, v1
    v_lshrrev_b32 v92, 10, v92
    v_mul_u32_u24 v93, 21, v92
    v_sub_u32 v93, v1, v93
    v_mul_u32_u24 v4, 1280, v92
    v_lshl_add_u32 v4, v93, 4, v4
    s_mul_i32 s37, s32, 21504
    s_add_u32 s37, s37, 8192
    s_mul_i32 s39, s33, 81920
    s_mul_i32 s40, s32, 320
    s_add_u32 s39, s39, s40
    s_mov_b32 s52, -1
    s_mov_b32 s53, 0x7fffffff
    s_mov_b32 s41, 21
    s_waitcnt lgkmcnt(0)
    s_mov_b32 s16, s4
    s_and_b32 s17, s5, 0xffff
    s_mov_b32 s18, 0x280000
    s_mov_b32 s19, 0x00020000
    s_mov_b64 exec, s[52:53]
qkv_xl:
    s_mov_b32 m0, s37
    s_add_u32 s37, s37, 1008
    s_sub_u32 s41, s41, 1
    buffer_load_dwordx4 v4, s[16:19], s39 offen lds
    s_add_u32 s39, s39, 3840
    s_cmp_lg_u32 s41, 0
    s_cbranch_scc1 qkv_xl
    s_mov_b64 exec, 0x1fffff
    s_mov_b32 m0, s37
    s_nop 0
    buffer_load_dwordx4 v4, s[16:19], s39 offen lds
    s_mov_b64 exec, -1
    s_mov_b32 s28, s12
    s_and_b32 s29, s13, 0xffff
    s_mov_b32 s30, 0x2500000
    s_mov_b32 s31, 0x00020000
    v_mul_u32_u24 v5, 336, v2
    v_lshl_add_u32 v5, v3, 4, v5
    v_add_u32 v5, 8192, v5
    s_cmp_eq_u32 s32, 3
    s_cbranch_scc1 qkv_w3
    s_mul_i32 s35, s34, 3
    s_add_u32 s35, s35, s32
    v_lshrrev_b32 v92, 2, v1
    v_and_b32 v93, 3, v1
    v_lshlrev_b32 v93, 4, v93
    s_cmp_eq_u32 s35, 21
    s_cselect_b32 s20, s10, s8
    s_cselect_b32 s21, s11, s9
    s_cmp_lt_u32 s35, 22
    s_cselect_b32 s22, 25600, 0
    s_lshl_b32 s45, s35, 6
    s_cmp_lt_u32 s35, 20
    s_cselect_b32 s20, s6, s20
    s_cselect_b32 s21, s7, s21
    s_cselect_b32 s22, 819200, s22
    s_mov_b32 s23, 0x00020000
    s_cselect_b32 s42, s45, 0
    s_movk_i32 s38, 1280
    s_cselect_b32 s38, s38, 40
    s_and_b32 s21, s21, 0xffff
    v_mad_u32_u24 v8, v92, s38, v93
    s_lshl_b32 s43, s38, 4
    s_mul_i32 s44, s32, 20480
    s_add_u32 s44, s44, 94208
    s_mov_b32 s46, s44
    s_mov_b32 s41, 12
qkv_wl:
    s_mov_b32 m0, s46
    s_add_u32 s46, s46, 1024
    s_sub_u32 s41, s41, 1
    buffer_load_dwordx4 v8, s[20:23], s42 offen lds
    s_add_u32 s42, s42, s43
    s_cmp_lg_u32 s41, 0
    s_cbranch_scc1 qkv_wl
    v_lshlrev_b32 v7, 9, v3
    v_bfe_u32 v92, v1, 2, 2
    v_lshl_add_u32 v7, v92, 6, v7
    v_bfe_u32 v92, v1, 4, 1
    v_lshl_add_u32 v7, v92, 5, v7
    v_and_b32 v92, 3, v1
    v_lshl_add_u32 v7, v92, 3, v7
    v_add_u32 v7, s44, v7
    v_mov_b32 v88, 0x3f803f80
    v_mov_b32 v89, 0x3f803f80
    v_mov_b32 v90, 0x3f803f80
    v_mov_b32 v91, 0x3f803f80
    v_mov_b32 v16, 0
    v_mov_b32 v17, 0
    v_mov_b32 v18, 0
    v_mov_b32 v19, 0
    v_mov_b32 v20, 0
    v_mov_b32 v21, 0
    v_mov_b32 v22, 0
    v_mov_b32 v23, 0
    v_mov_b32 v24, 0
    v_mov_b32 v25, 0
    v_mov_b32 v26, 0
    v_mov_b32 v27, 0
    v_mov_b32 v28, 0
    v_mov_b32 v29, 0
    v_mov_b32 v30, 0
    v_mov_b32 v31, 0
    v_mov_b32 v32, 0
    v_mov_b32 v33, 0
    v_mov_b32 v34, 0
    v_mov_b32 v35, 0
    v_mov_b32 v36, 0
    v_mov_b32 v37, 0
    v_mov_b32 v38, 0
    v_mov_b32 v39, 0
    v_mov_b32 v40, 0
    v_mov_b32 v41, 0
    v_mov_b32 v42, 0
    v_mov_b32 v43, 0
    v_mov_b32 v44, 0
    v_mov_b32 v45, 0
    v_mov_b32 v46, 0
    v_mov_b32 v47, 0
    v_mov_b32 v48, 0
    v_mov_b32 v49, 0
    v_mov_b32 v50, 0
    v_mov_b32 v51, 0
    v_mov_b32 v52, 0
    v_mov_b32 v53, 0
    v_mov_b32 v54, 0
    v_mov_b32 v55, 0
    v_mov_b32 v56, 0
    v_mov_b32 v57, 0
    v_mov_b32 v58, 0
    v_mov_b32 v59, 0
    v_mov_b32 v60, 0
    v_mov_b32 v61, 0
    v_mov_b32 v62, 0
    v_mov_b32 v63, 0
    s_waitcnt vmcnt(12)
    s_barrier
    s_waitcnt vmcnt(11)
    ds_read_b64_tr_b16 v[64:65], v7 offset:0
    ds_read_b64_tr_b16 v[66:67], v7 offset:256
    ds_read_b128 v[72:75], v5 offset:0
    ds_read_b128 v[76:79], v5 offset:10752
    s_mov_b32 s41, 4
    s_mov_b32 s46, s44
qkv_loop:
    v_add_u32 v6, 21504, v5
    s_sub_u32 s47, s46, s44
    s_xor_b32 s47, s47, 10240
    s_sub_u32 s48, s44, s46
    s_add_u32 s48, s48, s47
    v_add_u32 v9, s48, v7
    s_add_u32 s49, s44, s47
    s_waitcnt vmcnt(10)
    ds_read_b64_tr_b16 v[68:69], v7 offset:1024
    ds_read_b64_tr_b16 v[70:71], v7 offset:1280
    ds_read_b128 v[80:83], v5 offset:32
    ds_read_b128 v[84:87], v5 offset:10784
    s_add_u32 m0, s49, 2048
    s_waitcnt lgkmcnt(4)
    v_mfma_f32_32x32x16_bf16 v[16:31], v[64:67], v[72:75], v[16:31]
    buffer_load_dwordx4 v8, s[20:23], s42 offen lds
    s_add_u32 s42, s42, s43
    v_mfma_f32_32x32x16_bf16 v[32:47], v[64:67], v[76:79], v[32:47]
    v_mfma_f32_32x32x16_bf16 v[48:63], v[64:67], v[88:91], v[48:63]
    s_waitcnt vmcnt(10)
    ds_read_b64_tr_b16 v[64:65], v7 offset:2048
    ds_read_b64_tr_b16 v[66:67], v7 offset:2304
    ds_read_b128 v[72:75], v5 offset:64
    ds_read_b128 v[76:79], v5 offset:10816
    s_add_u32 m0, s49, 3072
    s_waitcnt lgkmcnt(4)
    v_mfma_f32_32x32x16_bf16 v[16:31], v[68:71], v[80:83], v[16:31]
    buffer_load_dwordx4 v8, s[20:23], s42 offen lds
    s_add_u32 s42, s42, s43
    v_mfma_f32_32x32x16_bf16 v[32:47], v[68:71], v[84:87], v[32:47]
    v_mfma_f32_32x32x16_bf16 v[48:63], v[68:71], v[88:91], v[48:63]
    s_waitcnt vmcnt(10)
    ds_read_b64_tr_b16 v[68:69], v7 offset:3072
    ds_read_b64_tr_b16 v[70:71], v7 offset:3328
    ds_read_b128 v[80:83], v5 offset:96
    ds_read_b128 v[84:87], v5 offset:10848
    s_add_u32 m0, s49, 4096
    s_waitcnt lgkmcnt(4)
    v_mfma_f32_32x32x16_bf16 v[16:31], v[64:67], v[72:75], v[16:31]
    buffer_load_dwordx4 v8, s[20:23], s42 offen lds
    s_add_u32 s42, s42, s43
    v_mfma_f32_32x32x16_bf16 v[32:47], v[64:67], v[76:79], v[32:47]
    v_mfma_f32_32x32x16_bf16 v[48:63], v[64:67], v[88:91], v[48:63]
    s_waitcnt vmcnt(10)
    ds_read_b64_tr_b16 v[64:65], v7 offset:4096
    ds_read_b64_tr_b16 v[66:67], v7 offset:4352
    ds_read_b128 v[72:75], v5 offset:128
    ds_read_b128 v[76:79], v5 offset:10880
    s_add_u32 m0, s49, 5120
    s_waitcnt lgkmcnt(4)
    v_mfma_f32_32x32x16_bf16 v[16:31], v[68:71], v[80:83], v[16:31]
    buffer_load_dwordx4 v8, s[20:23], s42 offen lds
    s_add_u32 s42, s42, s43
    v_mfma_f32_32x32x16_bf16 v[32:47], v[68:71], v[84:87], v[32:47]
    v_mfma_f32_32x32x16_bf16 v[48:63], v[68:71], v[88:91], v[48:63]
    s_waitcnt vmcnt(10)
    ds_read_b64_tr_b16 v[68:69], v7 offset:5120
    ds_read_b64_tr_b16 v[70:71], v7 offset:5376
    ds_read_b128 v[80:83], v5 offset:160
    ds_read_b128 v[84:87], v5 offset:10912
    s_add_u32 m0, s49, 6144
    s_waitcnt lgkmcnt(4)
    v_mfma_f32_32x32x16_bf16 v[16:31], v[64:67], v[72:75], v[16:31]
    buffer_load_dwordx4 v8, s[20:23], s42 offen lds
    s_add_u32 s42, s42, s43
    v_mfma_f32_32x32x16_bf16 v[32:47], v[64:67], v[76:79], v[32:47]
    v_mfma_f32_32x32x16_bf16 v[48:63], v[64:67], v[88:91], v[48:63]
    s_waitcnt vmcnt(10)
    ds_read_b64_tr_b16 v[64:65], v7 offset:6144
    ds_read_b64_tr_b16 v[66:67], v7 offset:6400
    ds_read_b128 v[72:75], v5 offset:192
    ds_read_b128 v[76:79], v5 offset:10944
    s_add_u32 m0, s49, 7168
    s_waitcnt lgkmcnt(4)
    v_mfma_f32_32x32x16_bf16 v[16:31], v[68:71], v[80:83], v[16:31]
    buffer_load_dwordx4 v8, s[20:23], s42 offen lds
    s_add_u32 s42, s42, s43
    v_mfma_f32_32x32x16_bf16 v[32:47], v[68:71], v[84:87], v[32:47]
    v_mfma_f32_32x32x16_bf16 v[48:63], v[68:71], v[88:91], v[48:63]
    s_waitcnt vmcnt(10)
    ds_read_b64_tr_b16 v[68:69], v7 offset:7168
    ds_read_b64_tr_b16 v[70:71], v7 offset:7424
    ds_read_b128 v[80:83], v5 offset:224
    ds_read_b128 v[84:87], v5 offset:10976
    s_add_u32 m0, s49, 8192
    s_waitcnt lgkmcnt(4)
    v_mfma_f32_32x32x16_bf16 v[16:31], v[64:67], v[72:75], v[16:31]
    buffer_load_dwordx4 v8, s[20:23], s42 offen lds
    s_add_u32 s42, s42, s43
    v_mfma_f32_32x32x16_bf16 v[32:47], v[64:67], v[76:79], v[32:47]
    v_mfma_f32_32x32x16_bf16 v[48:63], v[64:67], v[88:91], v[48:63]
    s_waitcnt vmcnt(10)
    ds_read_b64_tr_b16 v[64:65], v7 offset:8192
    ds_read_b64_tr_b16 v[66:67], v7 offset:8448
    ds_read_b128 v[72:75], v5 offset:256
    ds_read_b128 v[76:79], v5 offset:11008
    s_add_u32 m0, s49, 9216
    s_waitcnt lgkmcnt(4)
    v_mfma_f32_32x32x16_bf16 v[16:31], v[68:71], v[80:83], v[16:31]
    buffer_load_dwordx4 v8, s[20:23], s42 offen lds
    s_add_u32 s42, s42, s43
    v_mfma_f32_32x32x16_bf16 v[32:47], v[68:71], v[84:87], v[32:47]
    v_mfma_f32_32x32x16_bf16 v[48:63], v[68:71], v[88:91], v[48:63]
    s_waitcnt vmcnt(10)
    ds_read_b64_tr_b16 v[68:69], v7 offset:9216
    ds_read_b64_tr_b16 v[70:71], v7 offset:9472
    ds_read_b128 v[80:83], v5 offset:288
    ds_read_b128 v[84:87], v5 offset:11040
    s_add_u32 m0, s46, 0
    s_waitcnt lgkmcnt(4)
    v_mfma_f32_32x32x16_bf16 v[16:31], v[64:67], v[72:75], v[16:31]
    buffer_load_dwordx4 v8, s[20:23], s42 offen lds
    s_add_u32 s42, s42, s43
    v_mfma_f32_32x32x16_bf16 v[32:47], v[64:67], v[76:79], v[32:47]
    v_mfma_f32_32x32x16_bf16 v[48:63], v[64:67], v[88:91], v[48:63]
    s_waitcnt vmcnt(10)
    ds_read_b64_tr_b16 v[64:65], v9 offset:0
    ds_read_b64_tr_b16 v[66:67], v9 offset:256
    ds_read_b128 v[72:75], v6 offset:0
    ds_read_b128 v[76:79], v6 offset:10752
    s_add_u32 m0, s46, 1024
    s_waitcnt lgkmcnt(4)
    v_mfma_f32_32x32x16_bf16 v[16:31], v[68:71], v[80:83], v[16:31]
    buffer_load_dwordx4 v8, s[20:23], s42 offen lds
    s_add_u32 s42, s42, s43
    v_mfma_f32_32x32x16_bf16 v[32:47], v[68:71], v[84:87], v[32:47]
    v_mfma_f32_32x32x16_bf16 v[48:63], v[68:71], v[88:91], v[48:63]
    v_mov_b32 v5, v6
    v_mov_b32 v7, v9
    s_add_u32 s46, s44, s47
    s_sub_u32 s41, s41, 1
    s_cmp_lg_u32 s41, 0
    s_cbranch_scc1 qkv_loop
    s_waitcnt lgkmcnt(0)
    s_barrier
    s_cmp_ge_u32 s35, 22
    s_cbranch_scc1 qkv_end
    v_lshlrev_b32 v92, 3, v2
    ds_read_b64 v[94:95], v92 offset:0
    ds_read_b64 v[96:97], v92 offset:256
    s_mov_b32 s45, 0x3ea52b5c
    s_cmp_lt_u32 s35, 20
    s_cselect_b32 s45, s45, 1.0
    s_waitcnt lgkmcnt(0)
    v_mul_f32 v95, s45, v95
    v_mul_f32 v97, s45, v97
    v_fma_f32 v16, -v94, v48, v16
    v_mul_f32 v16, v16, v95
    v_fma_f32 v17, -v94, v49, v17
    v_mul_f32 v17, v17, v95
    v_fma_f32 v18, -v94, v50, v18
    v_mul_f32 v18, v18, v95
    v_fma_f32 v19, -v94, v51, v19
    v_mul_f32 v19, v19, v95
    v_fma_f32 v20, -v94, v52, v20
    v_mul_f32 v20, v20, v95
    v_fma_f32 v21, -v94, v53, v21
    v_mul_f32 v21, v21, v95
    v_fma_f32 v22, -v94, v54, v22
    v_mul_f32 v22, v22, v95
    v_fma_f32 v23, -v94, v55, v23
    v_mul_f32 v23, v23, v95
    v_fma_f32 v24, -v94, v56, v24
    v_mul_f32 v24, v24, v95
    v_fma_f32 v25, -v94, v57, v25
    v_mul_f32 v25, v25, v95
    v_fma_f32 v26, -v94, v58, v26
    v_mul_f32 v26, v26, v95
    v_fma_f32 v27, -v94, v59, v27
    v_mul_f32 v27, v27, v95
    v_fma_f32 v28, -v94, v60, v28
    v_mul_f32 v28, v28, v95
    v_fma_f32 v29, -v94, v61, v29
    v_mul_f32 v29, v29, v95
    v_fma_f32 v30, -v94, v62, v30
    v_mul_f32 v30, v30, v95
    v_fma_f32 v31, -v94, v63, v31
    v_mul_f32 v31, v31, v95
    v_fma_f32 v32, -v96, v48, v32
    v_mul_f32 v32, v32, v97
    v_fma_f32 v33, -v96, v49, v33
    v_mul_f32 v33, v33, v97
    v_fma_f32 v34, -v96, v50, v34
    v_mul_f32 v34, v34, v97
    v_fma_f32 v35, -v96, v51, v35
    v_mul_f32 v35, v35, v97
    v_fma_f32 v36, -v96, v52, v36
    v_mul_f32 v36, v36, v97
    v_fma_f32 v37, -v96, v53, v37
    v_mul_f32 v37, v37, v97
    v_fma_f32 v38, -v96, v54, v38
    v_mul_f32 v38, v38, v97
    v_fma_f32 v39, -v96, v55, v39
    v_mul_f32 v39, v39, v97
    v_fma_f32 v40, -v96, v56, v40
    v_mul_f32 v40, v40, v97
    v_fma_f32 v41, -v96, v57, v41
    v_mul_f32 v41, v41, v97
    v_fma_f32 v42, -v96, v58, v42
    v_mul_f32 v42, v42, v97
    v_fma_f32 v43, -v96, v59, v43
    v_mul_f32 v43, v43, v97
    v_fma_f32 v44, -v96, v60, v44
    v_mul_f32 v44, v44, v97
    v_fma_f32 v45, -v96, v61, v45
    v_mul_f32 v45, v45, v97
    v_fma_f32 v46, -v96, v62, v46
    v_mul_f32 v46, v46, v97
    v_fma_f32 v47, -v96, v63, v47
    v_mul_f32 v47, v47, v97
    s_cmp_ge_u32 s35, 20
    s_cbranch_scc1 qkv_kv
    s_mov_b32 s46, 3277
    s_lshl_b32 s38, s35, 5
    s_mul_i32 s48, s33, 81920
    s_add_u32 s48, s48, 2621440
    s_add_u32 s49, s48, 40960
    v_lshlrev_b32 v98, 2, v3
    v_add_u32 v98, s38, v98
    v_mul_u32_u24 v99, s46, v98
    v_lshrrev_b32 v99, 16, v99
    v_mul_u32_u24 v100, 20, v99
    v_sub_u32 v100, v98, v100
    v_mul_u32_u24 v101, 1280, v99
    v_lshrrev_b32 v102, 3, v100
    v_lshlrev_b32 v102, 9, v102
    v_lshl_add_u32 v102, v2, 4, v102
    v_and_b32 v103, 4, v100
    v_lshl_add_u32 v102, v103, 1, v102
    v_lshlrev_b32 v103, 3, v2
    v_add_u32 v103, 1024, v103
    v_cmp_gt_u32 vcc, 16, v100
    s_nop 1
    v_cndmask_b32 v102, v103, v102, vcc
    v_add_u32 v101, v101, v102
    v_cvt_pk_bf16_f32 v16, v16, v17
    v_cvt_pk_bf16_f32 v17, v18, v19
    buffer_store_dwordx2 v[16:17], v101, s[28:31], s48 offen
    v_cvt_pk_bf16_f32 v32, v32, v33
    v_cvt_pk_bf16_f32 v33, v34, v35
    buffer_store_dwordx2 v[32:33], v101, s[28:31], s49 offen
    v_lshlrev_b32 v98, 2, v3
    v_add_u32 v98, s38, v98
    v_add_u32 v98, 8, v98
    v_mul_u32_u24 v99, s46, v98
    v_lshrrev_b32 v99, 16, v99
    v_mul_u32_u24 v100, 20, v99
    v_sub_u32 v100, v98, v100
    v_mul_u32_u24 v101, 1280, v99
    v_lshrrev_b32 v102, 3, v100
    v_lshlrev_b32 v102, 9, v102
    v_lshl_add_u32 v102, v2, 4, v102
    v_and_b32 v103, 4, v100
    v_lshl_add_u32 v102, v103, 1, v102
    v_lshlrev_b32 v103, 3, v2
    v_add_u32 v103, 1024, v103
    v_cmp_gt_u32 vcc, 16, v100
    s_nop 1
    v_cndmask_b32 v102, v103, v102, vcc
    v_add_u32 v101, v101, v102
    v_cvt_pk_bf16_f32 v20, v20, v21
    v_cvt_pk_bf16_f32 v21, v22, v23
    buffer_store_dwordx2 v[20:21], v101, s[28:31], s48 offen
    v_cvt_pk_bf16_f32 v36, v36, v37
    v_cvt_pk_bf16_f32 v37, v38, v39
    buffer_store_dwordx2 v[36:37], v101, s[28:31], s49 offen
    v_lshlrev_b32 v98, 2, v3
    v_add_u32 v98, s38, v98
    v_add_u32 v98, 16, v98
    v_mul_u32_u24 v99, s46, v98
    v_lshrrev_b32 v99, 16, v99
    v_mul_u32_u24 v100, 20, v99
    v_sub_u32 v100, v98, v100
    v_mul_u32_u24 v101, 1280, v99
    v_lshrrev_b32 v102, 3, v100
    v_lshlrev_b32 v102, 9, v102
    v_lshl_add_u32 v102, v2, 4, v102
    v_and_b32 v103, 4, v100
    v_lshl_add_u32 v102, v103, 1, v102
    v_lshlrev_b32 v103, 3, v2
    v_add_u32 v103, 1024, v103
    v_cmp_gt_u32 vcc, 16, v100
    s_nop 1
    v_cndmask_b32 v102, v103, v102, vcc
    v_add_u32 v101, v101, v102
    v_cvt_pk_bf16_f32 v24, v24, v25
    v_cvt_pk_bf16_f32 v25, v26, v27
    buffer_store_dwordx2 v[24:25], v101, s[28:31], s48 offen
    v_cvt_pk_bf16_f32 v40, v40, v41
    v_cvt_pk_bf16_f32 v41, v42, v43
    buffer_store_dwordx2 v[40:41], v101, s[28:31], s49 offen
    v_lshlrev_b32 v98, 2, v3
    v_add_u32 v98, s38, v98
    v_add_u32 v98, 24, v98
    v_mul_u32_u24 v99, s46, v98
    v_lshrrev_b32 v99, 16, v99
    v_mul_u32_u24 v100, 20, v99
    v_sub_u32 v100, v98, v100
    v_mul_u32_u24 v101, 1280, v99
    v_lshrrev_b32 v102, 3, v100
    v_lshlrev_b32 v102, 9, v102
    v_lshl_add_u32 v102, v2, 4, v102
    v_and_b32 v103, 4, v100
    v_lshl_add_u32 v102, v103, 1, v102
    v_lshlrev_b32 v103, 3, v2
    v_add_u32 v103, 1024, v103
    v_cmp_gt_u32 vcc, 16, v100
    s_nop 1
    v_cndmask_b32 v102, v103, v102, vcc
    v_add_u32 v101, v101, v102
    v_cvt_pk_bf16_f32 v28, v28, v29
    v_cvt_pk_bf16_f32 v29, v30, v31
    buffer_store_dwordx2 v[28:29], v101, s[28:31], s48 offen
    v_cvt_pk_bf16_f32 v44, v44, v45
    v_cvt_pk_bf16_f32 v45, v46, v47
    buffer_store_dwordx2 v[44:45], v101, s[28:31], s49 offen
    s_branch qkv_fin
qkv_kv:
    v_cmp_eq_u32 s[54:55], 0, v3
    v_mul_f32 v104, v24, v24
    v_fmac_f32 v104, v25, v25
    v_fmac_f32 v104, v26, v26
    v_fmac_f32 v104, v27, v27
    v_cndmask_b32 v104, 0, v104, s[54:55]
    v_fmac_f32 v104, v16, v16
    v_fmac_f32 v104, v17, v17
    v_fmac_f32 v104, v18, v18
    v_fmac_f32 v104, v19, v19
    v_fmac_f32 v104, v20, v20
    v_fmac_f32 v104, v21, v21
    v_fmac_f32 v104, v22, v22
    v_fmac_f32 v104, v23, v23
    v_mov_b32 v106, v104
    s_nop 1
    v_permlane32_swap_b32 v104, v106
    v_add_f32 v104, v104, v106
    v_cvt_pk_bf16_f32 v16, v16, v17
    v_cvt_pk_bf16_f32 v17, v18, v19
    v_cvt_pk_bf16_f32 v20, v20, v21
    v_cvt_pk_bf16_f32 v21, v22, v23
    v_cvt_pk_bf16_f32 v24, v24, v25
    v_cvt_pk_bf16_f32 v25, v26, v27
    v_mul_f32 v105, v40, v40
    v_fmac_f32 v105, v41, v41
    v_fmac_f32 v105, v42, v42
    v_fmac_f32 v105, v43, v43
    v_cndmask_b32 v105, 0, v105, s[54:55]
    v_fmac_f32 v105, v32, v32
    v_fmac_f32 v105, v33, v33
    v_fmac_f32 v105, v34, v34
    v_fmac_f32 v105, v35, v35
    v_fmac_f32 v105, v36, v36
    v_fmac_f32 v105, v37, v37
    v_fmac_f32 v105, v38, v38
    v_fmac_f32 v105, v39, v39
    v_mov_b32 v107, v105
    s_nop 1
    v_permlane32_swap_b32 v105, v107
    v_add_f32 v105, v105, v107
    v_cvt_pk_bf16_f32 v32, v32, v33
    v_cvt_pk_bf16_f32 v33, v34, v35
    v_cvt_pk_bf16_f32 v36, v36, v37
    v_cvt_pk_bf16_f32 v37, v38, v39
    v_cvt_pk_bf16_f32 v40, v40, v41
    v_cvt_pk_bf16_f32 v41, v42, v43
    v_max_u32 v104, v104, v105
    v_mov_b32 v105, 0
    ds_max_u32 v105, v104 offset:1024
    s_cmp_eq_u32 s35, 21
    s_cbranch_scc1 qkv_v
    s_mul_i32 s48, s33, 5248
    s_add_u32 s48, s48, 5242880
    s_add_u32 s49, s48, 2624
    v_lshlrev_b32 v100, 2, v3
    v_mov_b32 v101, 0
    v_lshrrev_b32 v102, 3, v100
    v_lshlrev_b32 v102, 9, v102
    v_lshl_add_u32 v102, v2, 4, v102
    v_and_b32 v103, 4, v100
    v_lshl_add_u32 v102, v103, 1, v102
    v_lshlrev_b32 v103, 3, v2
    v_add_u32 v103, 1024, v103
    v_cmp_gt_u32 vcc, 16, v100
    s_nop 1
    v_cndmask_b32 v102, v103, v102, vcc
    v_add_u32 v101, v101, v102
    buffer_store_dwordx2 v[16:17], v101, s[28:31], s48 offen
    buffer_store_dwordx2 v[32:33], v101, s[28:31], s49 offen
    v_lshlrev_b32 v100, 2, v3
    v_add_u32 v100, 8, v100
    v_mov_b32 v101, 0
    v_lshrrev_b32 v102, 3, v100
    v_lshlrev_b32 v102, 9, v102
    v_lshl_add_u32 v102, v2, 4, v102
    v_and_b32 v103, 4, v100
    v_lshl_add_u32 v102, v103, 1, v102
    v_lshlrev_b32 v103, 3, v2
    v_add_u32 v103, 1024, v103
    v_cmp_gt_u32 vcc, 16, v100
    s_nop 1
    v_cndmask_b32 v102, v103, v102, vcc
    v_add_u32 v101, v101, v102
    buffer_store_dwordx2 v[20:21], v101, s[28:31], s48 offen
    buffer_store_dwordx2 v[36:37], v101, s[28:31], s49 offen
    v_lshlrev_b32 v100, 2, v3
    v_add_u32 v100, 16, v100
    v_mov_b32 v101, 0
    v_lshrrev_b32 v102, 3, v100
    v_lshlrev_b32 v102, 9, v102
    v_lshl_add_u32 v102, v2, 4, v102
    v_and_b32 v103, 4, v100
    v_lshl_add_u32 v102, v103, 1, v102
    v_lshlrev_b32 v103, 3, v2
    v_add_u32 v103, 1024, v103
    v_cmp_gt_u32 vcc, 16, v100
    s_nop 1
    v_cndmask_b32 v102, v103, v102, vcc
    v_add_u32 v101, v101, v102
    s_mov_b64 exec, 0xffffffff
    buffer_store_dwordx2 v[24:25], v101, s[28:31], s48 offen
    buffer_store_dwordx2 v[40:41], v101, s[28:31], s49 offen
    s_mov_b64 exec, -1
    s_branch qkv_kn
qkv_v:
    s_mul_i32 s48, s33, 5248
    s_add_u32 s48, s48, 5244160
    s_add_u32 s49, s48, 2624
    v_lshrrev_b32 v102, 4, v2
    v_lshlrev_b32 v102, 1, v102
    v_bfe_u32 v103, v2, 2, 1
    v_add_u32 v102, v102, v103
    v_mul_u32_u24 v102, 21, v102
    v_lshl_add_u32 v102, v3, 2, v102
    v_lshlrev_b32 v101, 4, v102
    v_and_b32 v102, 3, v2
    v_lshl_add_u32 v101, v102, 1, v101
    v_bfe_u32 v102, v2, 3, 1
    v_lshl_add_u32 v101, v102, 3, v101
    buffer_store_short v16, v101, s[28:31], s48 offen offset:0
    buffer_store_short_d16_hi v16, v101, s[28:31], s48 offen offset:16
    buffer_store_short v17, v101, s[28:31], s48 offen offset:32
    buffer_store_short_d16_hi v17, v101, s[28:31], s48 offen offset:48
    buffer_store_short v32, v101, s[28:31], s49 offen offset:0
    buffer_store_short_d16_hi v32, v101, s[28:31], s49 offen offset:16
    buffer_store_short v33, v101, s[28:31], s49 offen offset:32
    buffer_store_short_d16_hi v33, v101, s[28:31], s49 offen offset:48
    buffer_store_short v20, v101, s[28:31], s48 offen offset:128
    buffer_store_short_d16_hi v20, v101, s[28:31], s48 offen offset:144
    buffer_store_short v21, v101, s[28:31], s48 offen offset:160
    buffer_store_short_d16_hi v21, v101, s[28:31], s48 offen offset:176
    buffer_store_short v36, v101, s[28:31], s49 offen offset:128
    buffer_store_short_d16_hi v36, v101, s[28:31], s49 offen offset:144
    buffer_store_short v37, v101, s[28:31], s49 offen offset:160
    buffer_store_short_d16_hi v37, v101, s[28:31], s49 offen offset:176
    s_mov_b64 exec, 0xffffffff
    buffer_store_short v24, v101, s[28:31], s48 offen offset:256
    buffer_store_short_d16_hi v24, v101, s[28:31], s48 offen offset:272
    buffer_store_short v25, v101, s[28:31], s48 offen offset:288
    buffer_store_short_d16_hi v25, v101, s[28:31], s48 offen offset:304
    buffer_store_short v40, v101, s[28:31], s49 offen offset:256
    buffer_store_short_d16_hi v40, v101, s[28:31], s49 offen offset:272
    buffer_store_short v41, v101, s[28:31], s49 offen offset:288
    buffer_store_short_d16_hi v41, v101, s[28:31], s49 offen offset:304
    s_add_u32 s48, s48, 320
    v_and_b32 v102, 3, v1
    v_mul_u32_u24 v101, 336, v102
    v_lshrrev_b32 v102, 2, v1
    v_mul_u32_u24 v102, 2624, v102
    v_add_u32 v101, v101, v102
    s_mov_b64 exec, 0xff
    buffer_store_dwordx4 v[88:91], v101, s[28:31], s48 offen
    s_mov_b64 exec, -1
qkv_kn:
    s_waitcnt lgkmcnt(0)
    ds_read_b32 v104, v105 offset:1024
    s_sub_u32 s48, s35, 20
    s_lshl_b32 s48, s48, 5
    s_add_u32 s48, s48, s33
    s_lshl_b32 s48, s48, 2
    s_add_u32 s48, s48, 5414912
    s_waitcnt lgkmcnt(0)
    buffer_store_dword v104, v105, s[28:31], s48 offen
qkv_fin:
    s_endpgm
qkv_w3:
    v_mul_u32_u24 v7, 336, v1
    v_add_u32 v7, 8192, v7
    v_mov_b32 v100, 0x3f803f80
    v_mov_b32 v96, 0
    v_mov_b32 v97, 0
    v_mov_b32 v98, 0
    v_mov_b32 v99, 0
    ds_write_b32 v96, v96 offset:1024
    s_waitcnt vmcnt(0) lgkmcnt(0)
    s_barrier
    s_mov_b32 s60, s56
    s_and_b32 s61, s57, 0xffff
    s_mov_b32 s62, 0x1e0000
    s_mov_b32 s63, 0x00020000
    s_mov_b32 s64, s58
    s_and_b32 s65, s59, 0xffff
    s_mov_b32 s66, 0x1e0000
    s_mov_b32 s67, 0x00020000
    v_mul_u32_u24 v104, 43, v1
    v_lshrrev_b32 v104, 9, v104
    v_mul_u32_u24 v105, 12, v104
    v_sub_u32 v105, v1, v105
    v_mul_u32_u24 v104, 3072, v104
    v_lshl_add_u32 v104, v105, 6, v104
    s_lshr_b32 s44, s2, 3
    s_mul_i32 s44, s44, 61440
    s_bfe_u32 s38, s2, 0x20001
    s_mul_i32 s38, s38, 768
    s_add_u32 s44, s44, s38
    s_mov_b32 s53, 0x0fffffff
    s_mov_b64 exec, s[52:53]
    buffer_load_dword v106, v104, s[60:63], s44 offen
    buffer_load_dword v106, v104, s[64:67], s44 offen
    s_add_u32 s44, s44, 15360
    buffer_load_dword v106, v104, s[60:63], s44 offen
    buffer_load_dword v106, v104, s[64:67], s44 offen
    s_add_u32 s44, s44, 15360
    buffer_load_dword v106, v104, s[60:63], s44 offen
    buffer_load_dword v106, v104, s[64:67], s44 offen
    s_add_u32 s44, s44, 15360
    buffer_load_dword v106, v104, s[60:63], s44 offen
    buffer_load_dword v106, v104, s[64:67], s44 offen
    s_add_u32 s44, s44, 15360
    s_mov_b64 exec, -1
    s_mov_b32 s41, 4
qkv_sl:
    ds_read_b128 v[16:19], v7 offset:0
    ds_read_b128 v[20:23], v7 offset:16
    ds_read_b128 v[24:27], v7 offset:32
    ds_read_b128 v[28:31], v7 offset:48
    ds_read_b128 v[32:35], v7 offset:64
    ds_read_b128 v[36:39], v7 offset:80
    ds_read_b128 v[40:43], v7 offset:96
    ds_read_b128 v[44:47], v7 offset:112
    ds_read_b128 v[48:51], v7 offset:128
    ds_read_b128 v[52:55], v7 offset:144
    ds_read_b128 v[56:59], v7 offset:160
    ds_read_b128 v[60:63], v7 offset:176
    ds_read_b128 v[64:67], v7 offset:192
    ds_read_b128 v[68:71], v7 offset:208
    ds_read_b128 v[72:75], v7 offset:224
    ds_read_b128 v[76:79], v7 offset:240
    ds_read_b128 v[80:83], v7 offset:256
    ds_read_b128 v[84:87], v7 offset:272
    ds_read_b128 v[88:91], v7 offset:288
    ds_read_b128 v[92:95], v7 offset:304
    s_waitcnt lgkmcnt(15)
    v_dot2_f32_bf16 v96, v16, v100, v96
    v_dot2_f32_bf16 v97, v16, v16, v97
    v_dot2_f32_bf16 v98, v17, v100, v98
    v_dot2_f32_bf16 v99, v17, v17, v99
    v_dot2_f32_bf16 v96, v18, v100, v96
    v_dot2_f32_bf16 v97, v18, v18, v97
    v_dot2_f32_bf16 v98, v19, v100, v98
    v_dot2_f32_bf16 v99, v19, v19, v99
    s_waitcnt lgkmcnt(15)
    v_dot2_f32_bf16 v96, v20, v100, v96
    v_dot2_f32_bf16 v97, v20, v20, v97
    v_dot2_f32_bf16 v98, v21, v100, v98
    v_dot2_f32_bf16 v99, v21, v21, v99
    v_dot2_f32_bf16 v96, v22, v100, v96
    v_dot2_f32_bf16 v97, v22, v22, v97
    v_dot2_f32_bf16 v98, v23, v100, v98
    v_dot2_f32_bf16 v99, v23, v23, v99
    s_waitcnt lgkmcnt(15)
    v_dot2_f32_bf16 v96, v24, v100, v96
    v_dot2_f32_bf16 v97, v24, v24, v97
    v_dot2_f32_bf16 v98, v25, v100, v98
    v_dot2_f32_bf16 v99, v25, v25, v99
    v_dot2_f32_bf16 v96, v26, v100, v96
    v_dot2_f32_bf16 v97, v26, v26, v97
    v_dot2_f32_bf16 v98, v27, v100, v98
    v_dot2_f32_bf16 v99, v27, v27, v99
    s_waitcnt lgkmcnt(15)
    v_dot2_f32_bf16 v96, v28, v100, v96
    v_dot2_f32_bf16 v97, v28, v28, v97
    v_dot2_f32_bf16 v98, v29, v100, v98
    v_dot2_f32_bf16 v99, v29, v29, v99
    v_dot2_f32_bf16 v96, v30, v100, v96
    v_dot2_f32_bf16 v97, v30, v30, v97
    v_dot2_f32_bf16 v98, v31, v100, v98
    v_dot2_f32_bf16 v99, v31, v31, v99
    s_waitcnt lgkmcnt(15)
    v_dot2_f32_bf16 v96, v32, v100, v96
    v_dot2_f32_bf16 v97, v32, v32, v97
    v_dot2_f32_bf16 v98, v33, v100, v98
    v_dot2_f32_bf16 v99, v33, v33, v99
    v_dot2_f32_bf16 v96, v34, v100, v96
    v_dot2_f32_bf16 v97, v34, v34, v97
    v_dot2_f32_bf16 v98, v35, v100, v98
    v_dot2_f32_bf16 v99, v35, v35, v99
    s_waitcnt lgkmcnt(14)
    v_dot2_f32_bf16 v96, v36, v100, v96
    v_dot2_f32_bf16 v97, v36, v36, v97
    v_dot2_f32_bf16 v98, v37, v100, v98
    v_dot2_f32_bf16 v99, v37, v37, v99
    v_dot2_f32_bf16 v96, v38, v100, v96
    v_dot2_f32_bf16 v97, v38, v38, v97
    v_dot2_f32_bf16 v98, v39, v100, v98
    v_dot2_f32_bf16 v99, v39, v39, v99
    s_waitcnt lgkmcnt(13)
    v_dot2_f32_bf16 v96, v40, v100, v96
    v_dot2_f32_bf16 v97, v40, v40, v97
    v_dot2_f32_bf16 v98, v41, v100, v98
    v_dot2_f32_bf16 v99, v41, v41, v99
    v_dot2_f32_bf16 v96, v42, v100, v96
    v_dot2_f32_bf16 v97, v42, v42, v97
    v_dot2_f32_bf16 v98, v43, v100, v98
    v_dot2_f32_bf16 v99, v43, v43, v99
    s_waitcnt lgkmcnt(12)
    v_dot2_f32_bf16 v96, v44, v100, v96
    v_dot2_f32_bf16 v97, v44, v44, v97
    v_dot2_f32_bf16 v98, v45, v100, v98
    v_dot2_f32_bf16 v99, v45, v45, v99
    v_dot2_f32_bf16 v96, v46, v100, v96
    v_dot2_f32_bf16 v97, v46, v46, v97
    v_dot2_f32_bf16 v98, v47, v100, v98
    v_dot2_f32_bf16 v99, v47, v47, v99
    s_waitcnt lgkmcnt(11)
    v_dot2_f32_bf16 v96, v48, v100, v96
    v_dot2_f32_bf16 v97, v48, v48, v97
    v_dot2_f32_bf16 v98, v49, v100, v98
    v_dot2_f32_bf16 v99, v49, v49, v99
    v_dot2_f32_bf16 v96, v50, v100, v96
    v_dot2_f32_bf16 v97, v50, v50, v97
    v_dot2_f32_bf16 v98, v51, v100, v98
    v_dot2_f32_bf16 v99, v51, v51, v99
    s_waitcnt lgkmcnt(10)
    v_dot2_f32_bf16 v96, v52, v100, v96
    v_dot2_f32_bf16 v97, v52, v52, v97
    v_dot2_f32_bf16 v98, v53, v100, v98
    v_dot2_f32_bf16 v99, v53, v53, v99
    v_dot2_f32_bf16 v96, v54, v100, v96
    v_dot2_f32_bf16 v97, v54, v54, v97
    v_dot2_f32_bf16 v98, v55, v100, v98
    v_dot2_f32_bf16 v99, v55, v55, v99
    s_waitcnt lgkmcnt(9)
    v_dot2_f32_bf16 v96, v56, v100, v96
    v_dot2_f32_bf16 v97, v56, v56, v97
    v_dot2_f32_bf16 v98, v57, v100, v98
    v_dot2_f32_bf16 v99, v57, v57, v99
    v_dot2_f32_bf16 v96, v58, v100, v96
    v_dot2_f32_bf16 v97, v58, v58, v97
    v_dot2_f32_bf16 v98, v59, v100, v98
    v_dot2_f32_bf16 v99, v59, v59, v99
    s_waitcnt lgkmcnt(8)
    v_dot2_f32_bf16 v96, v60, v100, v96
    v_dot2_f32_bf16 v97, v60, v60, v97
    v_dot2_f32_bf16 v98, v61, v100, v98
    v_dot2_f32_bf16 v99, v61, v61, v99
    v_dot2_f32_bf16 v96, v62, v100, v96
    v_dot2_f32_bf16 v97, v62, v62, v97
    v_dot2_f32_bf16 v98, v63, v100, v98
    v_dot2_f32_bf16 v99, v63, v63, v99
    s_waitcnt lgkmcnt(7)
    v_dot2_f32_bf16 v96, v64, v100, v96
    v_dot2_f32_bf16 v97, v64, v64, v97
    v_dot2_f32_bf16 v98, v65, v100, v98
    v_dot2_f32_bf16 v99, v65, v65, v99
    v_dot2_f32_bf16 v96, v66, v100, v96
    v_dot2_f32_bf16 v97, v66, v66, v97
    v_dot2_f32_bf16 v98, v67, v100, v98
    v_dot2_f32_bf16 v99, v67, v67, v99
    s_waitcnt lgkmcnt(6)
    v_dot2_f32_bf16 v96, v68, v100, v96
    v_dot2_f32_bf16 v97, v68, v68, v97
    v_dot2_f32_bf16 v98, v69, v100, v98
    v_dot2_f32_bf16 v99, v69, v69, v99
    v_dot2_f32_bf16 v96, v70, v100, v96
    v_dot2_f32_bf16 v97, v70, v70, v97
    v_dot2_f32_bf16 v98, v71, v100, v98
    v_dot2_f32_bf16 v99, v71, v71, v99
    s_waitcnt lgkmcnt(5)
    v_dot2_f32_bf16 v96, v72, v100, v96
    v_dot2_f32_bf16 v97, v72, v72, v97
    v_dot2_f32_bf16 v98, v73, v100, v98
    v_dot2_f32_bf16 v99, v73, v73, v99
    v_dot2_f32_bf16 v96, v74, v100, v96
    v_dot2_f32_bf16 v97, v74, v74, v97
    v_dot2_f32_bf16 v98, v75, v100, v98
    v_dot2_f32_bf16 v99, v75, v75, v99
    s_waitcnt lgkmcnt(4)
    v_dot2_f32_bf16 v96, v76, v100, v96
    v_dot2_f32_bf16 v97, v76, v76, v97
    v_dot2_f32_bf16 v98, v77, v100, v98
    v_dot2_f32_bf16 v99, v77, v77, v99
    v_dot2_f32_bf16 v96, v78, v100, v96
    v_dot2_f32_bf16 v97, v78, v78, v97
    v_dot2_f32_bf16 v98, v79, v100, v98
    v_dot2_f32_bf16 v99, v79, v79, v99
    s_waitcnt lgkmcnt(3)
    v_dot2_f32_bf16 v96, v80, v100, v96
    v_dot2_f32_bf16 v97, v80, v80, v97
    v_dot2_f32_bf16 v98, v81, v100, v98
    v_dot2_f32_bf16 v99, v81, v81, v99
    v_dot2_f32_bf16 v96, v82, v100, v96
    v_dot2_f32_bf16 v97, v82, v82, v97
    v_dot2_f32_bf16 v98, v83, v100, v98
    v_dot2_f32_bf16 v99, v83, v83, v99
    s_waitcnt lgkmcnt(2)
    v_dot2_f32_bf16 v96, v84, v100, v96
    v_dot2_f32_bf16 v97, v84, v84, v97
    v_dot2_f32_bf16 v98, v85, v100, v98
    v_dot2_f32_bf16 v99, v85, v85, v99
    v_dot2_f32_bf16 v96, v86, v100, v96
    v_dot2_f32_bf16 v97, v86, v86, v97
    v_dot2_f32_bf16 v98, v87, v100, v98
    v_dot2_f32_bf16 v99, v87, v87, v99
    s_waitcnt lgkmcnt(1)
    v_dot2_f32_bf16 v96, v88, v100, v96
    v_dot2_f32_bf16 v97, v88, v88, v97
    v_dot2_f32_bf16 v98, v89, v100, v98
    v_dot2_f32_bf16 v99, v89, v89, v99
    v_dot2_f32_bf16 v96, v90, v100, v96
    v_dot2_f32_bf16 v97, v90, v90, v97
    v_dot2_f32_bf16 v98, v91, v100, v98
    v_dot2_f32_bf16 v99, v91, v91, v99
    s_waitcnt lgkmcnt(0)
    v_dot2_f32_bf16 v96, v92, v100, v96
    v_dot2_f32_bf16 v97, v92, v92, v97
    v_dot2_f32_bf16 v98, v93, v100, v98
    v_dot2_f32_bf16 v99, v93, v93, v99
    v_dot2_f32_bf16 v96, v94, v100, v96
    v_dot2_f32_bf16 v97, v94, v94, v97
    v_dot2_f32_bf16 v98, v95, v100, v98
    v_dot2_f32_bf16 v99, v95, v95, v99
    v_add_u32 v7, 21504, v7
    s_sub_u32 s41, s41, 1
    s_cmp_lg_u32 s41, 0
    s_cbranch_scc1 qkv_sl
    s_mov_b32 s45, 0x3acccccd
    s_mov_b32 s46, 0x3727c5ac
    v_pk_add_f32 v[96:97], v[96:97], v[98:99]
    v_mul_f32 v96, s45, v96
    v_mul_f32 v97, s45, v97
    v_fma_f32 v97, -v96, v96, v97
    v_max_f32 v97, 0, v97
    v_cvt_pk_bf16_f32 v102, v96, v97
    v_and_b32 v101, 0xffff0000, v102
    v_lshlrev_b32 v102, 16, v102
    v_add_f32 v101, s46, v101
    v_cvt_pk_bf16_f32 v101, v101, v101
    v_lshlrev_b32 v101, 16, v101
    v_sqrt_f32 v101, v101
    s_nop 0
    v_cvt_pk_bf16_f32 v101, v101, v101
    v_lshlrev_b32 v101, 16, v101
    v_rcp_f32 v103, v101
    v_lshlrev_b32 v92, 3, v1
    ds_write_b64 v92, v[102:103] offset:0
    s_waitcnt lgkmcnt(0)
    s_barrier
    v_lshlrev_b32 v92, 3, v2
    ds_read_b64 v[94:95], v92 offset:0
    ds_read_b64 v[96:97], v92 offset:256
    s_add_u32 s41, s34, 0
    s_mul_i32 s42, s41, 26
    s_lshr_b32 s42, s42, 8
    s_mul_i32 s43, s42, 21184
    s_lshl_b32 s41, s41, 5
    s_add_u32 s43, s43, s41
    v_add_u32 v98, s43, v5
    ds_read_b128 v[16:19], v98 offset:0
    s_add_u32 s41, s34, 8
    s_mul_i32 s42, s41, 26
    s_lshr_b32 s42, s42, 8
    s_mul_i32 s43, s42, 21184
    s_lshl_b32 s41, s41, 5
    s_add_u32 s43, s43, s41
    v_add_u32 v98, s43, v5
    ds_read_b128 v[20:23], v98 offset:0
    s_add_u32 s41, s34, 16
    s_mul_i32 s42, s41, 26
    s_lshr_b32 s42, s42, 8
    s_mul_i32 s43, s42, 21184
    s_lshl_b32 s41, s41, 5
    s_add_u32 s43, s43, s41
    v_add_u32 v98, s43, v5
    ds_read_b128 v[24:27], v98 offset:0
    s_add_u32 s41, s34, 24
    s_mul_i32 s42, s41, 26
    s_lshr_b32 s42, s42, 8
    s_mul_i32 s43, s42, 21184
    s_lshl_b32 s41, s41, 5
    s_add_u32 s43, s43, s41
    v_add_u32 v98, s43, v5
    ds_read_b128 v[28:31], v98 offset:0
    s_add_u32 s41, s34, 32
    s_mul_i32 s42, s41, 26
    s_lshr_b32 s42, s42, 8
    s_mul_i32 s43, s42, 21184
    s_lshl_b32 s41, s41, 5
    s_add_u32 s43, s43, s41
    v_add_u32 v98, s43, v5
    ds_read_b128 v[32:35], v98 offset:0
    s_add_u32 s41, s34, 0
    s_mul_i32 s42, s41, 26
    s_lshr_b32 s42, s42, 8
    s_mul_i32 s43, s42, 21184
    s_lshl_b32 s41, s41, 5
    s_add_u32 s43, s43, s41
    v_add_u32 v98, s43, v5
    ds_read_b128 v[36:39], v98 offset:10752
    s_add_u32 s41, s34, 8
    s_mul_i32 s42, s41, 26
    s_lshr_b32 s42, s42, 8
    s_mul_i32 s43, s42, 21184
    s_lshl_b32 s41, s41, 5
    s_add_u32 s43, s43, s41
    v_add_u32 v98, s43, v5
    ds_read_b128 v[40:43], v98 offset:10752
    s_add_u32 s41, s34, 16
    s_mul_i32 s42, s41, 26
    s_lshr_b32 s42, s42, 8
    s_mul_i32 s43, s42, 21184
    s_lshl_b32 s41, s41, 5
    s_add_u32 s43, s43, s41
    v_add_u32 v98, s43, v5
    ds_read_b128 v[44:47], v98 offset:10752
    s_add_u32 s41, s34, 24
    s_mul_i32 s42, s41, 26
    s_lshr_b32 s42, s42, 8
    s_mul_i32 s43, s42, 21184
    s_lshl_b32 s41, s41, 5
    s_add_u32 s43, s43, s41
    v_add_u32 v98, s43, v5
    ds_read_b128 v[48:51], v98 offset:10752
    s_add_u32 s41, s34, 32
    s_mul_i32 s42, s41, 26
    s_lshr_b32 s42, s42, 8
    s_mul_i32 s43, s42, 21184
    s_lshl_b32 s41, s41, 5
    s_add_u32 s43, s43, s41
    v_add_u32 v98, s43, v5
    ds_read_b128 v[52:55], v98 offset:10752
    s_waitcnt lgkmcnt(10)
    v_mov_b32 v56, v95
    v_mov_b32 v57, v95
    v_mul_f32_e64 v58, -v94, v95
    v_mov_b32 v59, v58
    v_mov_b32 v60, v97
    v_mov_b32 v61, v97
    v_mul_f32_e64 v62, -v96, v97
    v_mov_b32 v63, v62
    s_mov_b32 s47, 0xffff0000
    v_lshlrev_b32 v92, 4, v1
    s_mul_i32 s39, s33, 80
    s_add_u32 s39, s39, s34
    s_lshl_b32 s39, s39, 10
    s_waitcnt lgkmcnt(9)
    v_lshlrev_b32 v64, 16, v16
    v_and_b32 v65, s47, v16
    v_pk_fma_f32 v[64:65], v[64:65], v[56:57], v[58:59]
    v_cvt_pk_bf16_f32 v16, v64, v65
    v_lshlrev_b32 v66, 16, v17
    v_and_b32 v67, s47, v17
    v_pk_fma_f32 v[66:67], v[66:67], v[56:57], v[58:59]
    v_cvt_pk_bf16_f32 v17, v66, v67
    v_lshlrev_b32 v68, 16, v18
    v_and_b32 v69, s47, v18
    v_pk_fma_f32 v[68:69], v[68:69], v[56:57], v[58:59]
    v_cvt_pk_bf16_f32 v18, v68, v69
    v_lshlrev_b32 v70, 16, v19
    v_and_b32 v71, s47, v19
    v_pk_fma_f32 v[70:71], v[70:71], v[56:57], v[58:59]
    v_cvt_pk_bf16_f32 v19, v70, v71
    buffer_store_dwordx4 v[16:19], v92, s[28:31], s39 offen
    s_add_u32 s39, s39, 8192
    s_waitcnt lgkmcnt(8)
    v_lshlrev_b32 v64, 16, v20
    v_and_b32 v65, s47, v20
    v_pk_fma_f32 v[64:65], v[64:65], v[56:57], v[58:59]
    v_cvt_pk_bf16_f32 v20, v64, v65
    v_lshlrev_b32 v66, 16, v21
    v_and_b32 v67, s47, v21
    v_pk_fma_f32 v[66:67], v[66:67], v[56:57], v[58:59]
    v_cvt_pk_bf16_f32 v21, v66, v67
    v_lshlrev_b32 v68, 16, v22
    v_and_b32 v69, s47, v22
    v_pk_fma_f32 v[68:69], v[68:69], v[56:57], v[58:59]
    v_cvt_pk_bf16_f32 v22, v68, v69
    v_lshlrev_b32 v70, 16, v23
    v_and_b32 v71, s47, v23
    v_pk_fma_f32 v[70:71], v[70:71], v[56:57], v[58:59]
    v_cvt_pk_bf16_f32 v23, v70, v71
    buffer_store_dwordx4 v[20:23], v92, s[28:31], s39 offen
    s_add_u32 s39, s39, 8192
    s_waitcnt lgkmcnt(7)
    v_lshlrev_b32 v64, 16, v24
    v_and_b32 v65, s47, v24
    v_pk_fma_f32 v[64:65], v[64:65], v[56:57], v[58:59]
    v_cvt_pk_bf16_f32 v24, v64, v65
    v_lshlrev_b32 v66, 16, v25
    v_and_b32 v67, s47, v25
    v_pk_fma_f32 v[66:67], v[66:67], v[56:57], v[58:59]
    v_cvt_pk_bf16_f32 v25, v66, v67
    v_lshlrev_b32 v68, 16, v26
    v_and_b32 v69, s47, v26
    v_pk_fma_f32 v[68:69], v[68:69], v[56:57], v[58:59]
    v_cvt_pk_bf16_f32 v26, v68, v69
    v_lshlrev_b32 v70, 16, v27
    v_and_b32 v71, s47, v27
    v_pk_fma_f32 v[70:71], v[70:71], v[56:57], v[58:59]
    v_cvt_pk_bf16_f32 v27, v70, v71
    buffer_store_dwordx4 v[24:27], v92, s[28:31], s39 offen
    s_add_u32 s39, s39, 8192
    s_waitcnt lgkmcnt(6)
    v_lshlrev_b32 v64, 16, v28
    v_and_b32 v65, s47, v28
    v_pk_fma_f32 v[64:65], v[64:65], v[56:57], v[58:59]
    v_cvt_pk_bf16_f32 v28, v64, v65
    v_lshlrev_b32 v66, 16, v29
    v_and_b32 v67, s47, v29
    v_pk_fma_f32 v[66:67], v[66:67], v[56:57], v[58:59]
    v_cvt_pk_bf16_f32 v29, v66, v67
    v_lshlrev_b32 v68, 16, v30
    v_and_b32 v69, s47, v30
    v_pk_fma_f32 v[68:69], v[68:69], v[56:57], v[58:59]
    v_cvt_pk_bf16_f32 v30, v68, v69
    v_lshlrev_b32 v70, 16, v31
    v_and_b32 v71, s47, v31
    v_pk_fma_f32 v[70:71], v[70:71], v[56:57], v[58:59]
    v_cvt_pk_bf16_f32 v31, v70, v71
    buffer_store_dwordx4 v[28:31], v92, s[28:31], s39 offen
    s_add_u32 s39, s39, 8192
    s_waitcnt lgkmcnt(5)
    v_lshlrev_b32 v64, 16, v32
    v_and_b32 v65, s47, v32
    v_pk_fma_f32 v[64:65], v[64:65], v[56:57], v[58:59]
    v_cvt_pk_bf16_f32 v32, v64, v65
    v_lshlrev_b32 v66, 16, v33
    v_and_b32 v67, s47, v33
    v_pk_fma_f32 v[66:67], v[66:67], v[56:57], v[58:59]
    v_cvt_pk_bf16_f32 v33, v66, v67
    v_lshlrev_b32 v68, 16, v34
    v_and_b32 v69, s47, v34
    v_pk_fma_f32 v[68:69], v[68:69], v[56:57], v[58:59]
    v_cvt_pk_bf16_f32 v34, v68, v69
    v_lshlrev_b32 v70, 16, v35
    v_and_b32 v71, s47, v35
    v_pk_fma_f32 v[70:71], v[70:71], v[56:57], v[58:59]
    v_cvt_pk_bf16_f32 v35, v70, v71
    buffer_store_dwordx4 v[32:35], v92, s[28:31], s39 offen
    s_add_u32 s39, s39, 8192
    s_waitcnt lgkmcnt(4)
    v_lshlrev_b32 v64, 16, v36
    v_and_b32 v65, s47, v36
    v_pk_fma_f32 v[64:65], v[64:65], v[60:61], v[62:63]
    v_cvt_pk_bf16_f32 v36, v64, v65
    v_lshlrev_b32 v66, 16, v37
    v_and_b32 v67, s47, v37
    v_pk_fma_f32 v[66:67], v[66:67], v[60:61], v[62:63]
    v_cvt_pk_bf16_f32 v37, v66, v67
    v_lshlrev_b32 v68, 16, v38
    v_and_b32 v69, s47, v38
    v_pk_fma_f32 v[68:69], v[68:69], v[60:61], v[62:63]
    v_cvt_pk_bf16_f32 v38, v68, v69
    v_lshlrev_b32 v70, 16, v39
    v_and_b32 v71, s47, v39
    v_pk_fma_f32 v[70:71], v[70:71], v[60:61], v[62:63]
    v_cvt_pk_bf16_f32 v39, v70, v71
    buffer_store_dwordx4 v[36:39], v92, s[28:31], s39 offen
    s_add_u32 s39, s39, 8192
    s_waitcnt lgkmcnt(3)
    v_lshlrev_b32 v64, 16, v40
    v_and_b32 v65, s47, v40
    v_pk_fma_f32 v[64:65], v[64:65], v[60:61], v[62:63]
    v_cvt_pk_bf16_f32 v40, v64, v65
    v_lshlrev_b32 v66, 16, v41
    v_and_b32 v67, s47, v41
    v_pk_fma_f32 v[66:67], v[66:67], v[60:61], v[62:63]
    v_cvt_pk_bf16_f32 v41, v66, v67
    v_lshlrev_b32 v68, 16, v42
    v_and_b32 v69, s47, v42
    v_pk_fma_f32 v[68:69], v[68:69], v[60:61], v[62:63]
    v_cvt_pk_bf16_f32 v42, v68, v69
    v_lshlrev_b32 v70, 16, v43
    v_and_b32 v71, s47, v43
    v_pk_fma_f32 v[70:71], v[70:71], v[60:61], v[62:63]
    v_cvt_pk_bf16_f32 v43, v70, v71
    buffer_store_dwordx4 v[40:43], v92, s[28:31], s39 offen
    s_add_u32 s39, s39, 8192
    s_waitcnt lgkmcnt(2)
    v_lshlrev_b32 v64, 16, v44
    v_and_b32 v65, s47, v44
    v_pk_fma_f32 v[64:65], v[64:65], v[60:61], v[62:63]
    v_cvt_pk_bf16_f32 v44, v64, v65
    v_lshlrev_b32 v66, 16, v45
    v_and_b32 v67, s47, v45
    v_pk_fma_f32 v[66:67], v[66:67], v[60:61], v[62:63]
    v_cvt_pk_bf16_f32 v45, v66, v67
    v_lshlrev_b32 v68, 16, v46
    v_and_b32 v69, s47, v46
    v_pk_fma_f32 v[68:69], v[68:69], v[60:61], v[62:63]
    v_cvt_pk_bf16_f32 v46, v68, v69
    v_lshlrev_b32 v70, 16, v47
    v_and_b32 v71, s47, v47
    v_pk_fma_f32 v[70:71], v[70:71], v[60:61], v[62:63]
    v_cvt_pk_bf16_f32 v47, v70, v71
    buffer_store_dwordx4 v[44:47], v92, s[28:31], s39 offen
    s_add_u32 s39, s39, 8192
    s_waitcnt lgkmcnt(1)
    v_lshlrev_b32 v64, 16, v48
    v_and_b32 v65, s47, v48
    v_pk_fma_f32 v[64:65], v[64:65], v[60:61], v[62:63]
    v_cvt_pk_bf16_f32 v48, v64, v65
    v_lshlrev_b32 v66, 16, v49
    v_and_b32 v67, s47, v49
    v_pk_fma_f32 v[66:67], v[66:67], v[60:61], v[62:63]
    v_cvt_pk_bf16_f32 v49, v66, v67
    v_lshlrev_b32 v68, 16, v50
    v_and_b32 v69, s47, v50
    v_pk_fma_f32 v[68:69], v[68:69], v[60:61], v[62:63]
    v_cvt_pk_bf16_f32 v50, v68, v69
    v_lshlrev_b32 v70, 16, v51
    v_and_b32 v71, s47, v51
    v_pk_fma_f32 v[70:71], v[70:71], v[60:61], v[62:63]
    v_cvt_pk_bf16_f32 v51, v70, v71
    buffer_store_dwordx4 v[48:51], v92, s[28:31], s39 offen
    s_add_u32 s39, s39, 8192
    s_waitcnt lgkmcnt(0)
    v_lshlrev_b32 v64, 16, v52
    v_and_b32 v65, s47, v52
    v_pk_fma_f32 v[64:65], v[64:65], v[60:61], v[62:63]
    v_cvt_pk_bf16_f32 v52, v64, v65
    v_lshlrev_b32 v66, 16, v53
    v_and_b32 v67, s47, v53
    v_pk_fma_f32 v[66:67], v[66:67], v[60:61], v[62:63]
    v_cvt_pk_bf16_f32 v53, v66, v67
    v_lshlrev_b32 v68, 16, v54
    v_and_b32 v69, s47, v54
    v_pk_fma_f32 v[68:69], v[68:69], v[60:61], v[62:63]
    v_cvt_pk_bf16_f32 v54, v68, v69
    v_lshlrev_b32 v70, 16, v55
    v_and_b32 v71, s47, v55
    v_pk_fma_f32 v[70:71], v[70:71], v[60:61], v[62:63]
    v_cvt_pk_bf16_f32 v55, v70, v71
    buffer_store_dwordx4 v[52:55], v92, s[28:31], s39 offen
    s_add_u32 s39, s39, 8192
    s_cmp_lg_u32 s2, 255
    s_cbranch_scc1 qkv_noct
    v_lshlrev_b32 v96, 8, v1
    v_mov_b32 v97, 0
    s_mov_b32 s44, 5423104
    s_mov_b32 s52, -1
    s_mov_b32 s53, 0xffff
    s_mov_b64 exec, s[52:53]
    buffer_store_dword v97, v96, s[28:31], s44 offen
    s_mov_b64 exec, -1
qkv_noct:
qkv_end:
    s_endpgm
.globl main_kernel
.p2align 8
.type main_kernel,@function
main_kernel:
    s_cmp_ge_u32 s2, 512
    s_cbranch_scc1 main_end
    s_cmp_ge_u32 s2, 256
    s_cbranch_scc1 main_ffn
    s_load_dwordx2 s[12:13], s[0:1], 88
    s_load_dwordx2 s[14:15], s[0:1], 32
    v_and_b32 v1, 63, v0
    v_lshrrev_b32 v228, 6, v0
    s_nop 0
    v_readfirstlane_b32 s32, v228
    v_and_b32 v2, 31, v0
    v_bfe_u32 v3, v0, 5, 1
    s_and_b32 s3, s2, 7
    s_lshr_b32 s36, s2, 5
    s_lshl_b32 s3, s3, 3
    s_add_u32 s33, s3, s36
    s_bfe_u32 s3, s2, 0x20003
    s_and_b32 s34, s32, 1
    s_lshr_b32 s36, s32, 1
    s_lshl_b32 s3, s3, 3
    s_lshl_b32 s36, s36, 2
    s_add_u32 s35, s3, s36
    v_lshlrev_b32 v4, 4, v1
    v_lshlrev_b32 v5, 3, v2
    v_add_u32 v5, 1024, v5
    v_mov_b32 v228, 0x80000000
    v_cmp_eq_u32 vcc, 0, v3
    s_nop 1
    v_cndmask_b32 v5, v228, v5, vcc
    v_mul_u32_u24 v6, 21, v3
    v_add_u32 v6, v6, v2
    v_lshlrev_b32 v6, 4, v6
    v_cmp_gt_u32 vcc, 21, v2
    s_nop 1
    v_cndmask_b32 v6, v228, v6, vcc
    s_waitcnt lgkmcnt(0)
    s_mov_b32 s28, s12
    s_and_b32 s29, s13, 0xffff
    s_mov_b32 s30, 0x2500000
    s_mov_b32 s31, 0x00020000
    v_lshlrev_b32 v236, 2, v1
    s_mov_b32 s36, 5414912
    buffer_load_dword v237, v236, s[28:31], s36 offen
    s_lshl_b32 s36, s33, 5
    s_add_u32 s36, s36, s35
    s_mul_i32 s36, s36, 1280
    s_add_u32 s36, s36, 2621440
    buffer_load_dwordx4 v[16:19], v4, s[28:31], s36 offen
    buffer_load_dwordx2 v[20:21], v5, s[28:31], s36 offen
    s_add_u32 s36, s36, 1280
    buffer_load_dwordx4 v[24:27], v4, s[28:31], s36 offen
    buffer_load_dwordx2 v[28:29], v5, s[28:31], s36 offen
    s_add_u32 s36, s36, 1280
    buffer_load_dwordx4 v[32:35], v4, s[28:31], s36 offen
    buffer_load_dwordx2 v[36:37], v5, s[28:31], s36 offen
    s_add_u32 s36, s36, 1280
    buffer_load_dwordx4 v[40:43], v4, s[28:31], s36 offen
    buffer_load_dwordx2 v[44:45], v5, s[28:31], s36 offen
    s_mul_i32 s37, s34, 83968
    s_add_u32 s37, s37, 5242880
    s_add_u32 s38, s37, 1280
    buffer_load_dwordx4 v[160:163], v4, s[28:31], s37 offen
    buffer_load_dwordx2 v[164:165], v5, s[28:31], s37 offen
    s_add_u32 s37, s37, 2624
    buffer_load_dwordx4 v[192:195], v6, s[28:31], s38 offen
    buffer_load_dwordx4 v[196:199], v6, s[28:31], s38 offen offset:672
    s_add_u32 s38, s38, 2624
    buffer_load_dwordx4 v[168:171], v4, s[28:31], s37 offen
    buffer_load_dwordx2 v[172:173], v5, s[28:31], s37 offen
    s_add_u32 s37, s37, 2624
    buffer_load_dwordx4 v[200:203], v6, s[28:31], s38 offen
    buffer_load_dwordx4 v[204:207], v6, s[28:31], s38 offen offset:672
    s_add_u32 s38, s38, 2624
    buffer_load_dwordx4 v[176:179], v4, s[28:31], s37 offen
    buffer_load_dwordx2 v[180:181], v5, s[28:31], s37 offen
    s_add_u32 s37, s37, 2624
    buffer_load_dwordx4 v[208:211], v6, s[28:31], s38 offen
    buffer_load_dwordx4 v[212:215], v6, s[28:31], s38 offen offset:672
    s_add_u32 s38, s38, 2624
    buffer_load_dwordx4 v[184:187], v4, s[28:31], s37 offen
    buffer_load_dwordx2 v[188:189], v5, s[28:31], s37 offen
    s_add_u32 s37, s37, 2624
    v_mov_b32 v22, 0
    v_mov_b32 v23, 0
    v_mov_b32 v30, 0
    v_mov_b32 v31, 0
    v_mov_b32 v38, 0
    v_mov_b32 v39, 0
    v_mov_b32 v46, 0
    v_mov_b32 v47, 0
    v_mov_b32 v166, 0
    v_mov_b32 v167, 0
    v_mov_b32 v174, 0
    v_mov_b32 v175, 0
    v_mov_b32 v182, 0
    v_mov_b32 v183, 0
    v_mov_b32 v190, 0
    v_mov_b32 v191, 0
    v_mov_b32 v144, 0
    v_mov_b32 v145, 0
    v_mov_b32 v146, 0
    v_mov_b32 v147, 0
    v_mov_b32 v148, 0
    v_mov_b32 v149, 0
    v_mov_b32 v150, 0
    v_mov_b32 v151, 0
    v_mov_b32 v152, 0
    v_mov_b32 v153, 0
    v_mov_b32 v154, 0
    v_mov_b32 v155, 0
    v_mov_b32 v156, 0
    v_mov_b32 v157, 0
    v_mov_b32 v158, 0
    v_mov_b32 v159, 0
    v_mfma_f32_32x32x16_bf16 v[48:63], v[144:147], v[144:147], 0
    v_mfma_f32_32x32x16_bf16 v[64:79], v[144:147], v[144:147], 0
    v_mfma_f32_32x32x16_bf16 v[80:95], v[144:147], v[144:147], 0
    v_mfma_f32_32x32x16_bf16 v[96:111], v[144:147], v[144:147], 0
    v_mov_b32 v216, 0
    v_mov_b32 v217, 0
    v_mov_b32 v218, 0
    v_mov_b32 v219, 0
    v_mov_b32 v220, 0
    v_mov_b32 v221, 0
    v_mov_b32 v222, 0
    v_mov_b32 v223, 0
    v_mov_b32 v224, 0
    v_mov_b32 v225, 0
    v_mov_b32 v226, 0
    v_mov_b32 v227, 0
    s_waitcnt vmcnt(22)
    v_max_u32_dpp v237, v237, v237 row_ror:1 row_mask:0xf bank_mask:0xf
    s_nop 1
    v_max_u32_dpp v237, v237, v237 row_ror:2 row_mask:0xf bank_mask:0xf
    s_nop 1
    v_max_u32_dpp v237, v237, v237 row_ror:4 row_mask:0xf bank_mask:0xf
    s_nop 1
    v_max_u32_dpp v237, v237, v237 row_ror:8 row_mask:0xf bank_mask:0xf
    s_nop 0
    v_readlane_b32 s64, v237, 0
    v_readlane_b32 s65, v237, 16
    v_readlane_b32 s44, v237, 32
    v_readlane_b32 s45, v237, 48
    s_max_u32 s64, s64, s65
    s_max_u32 s44, s44, s45
    s_waitcnt vmcnt(14)
    v_mov_b32 v228, 0
    v_mov_b32 v229, 0
    v_mov_b32 v230, 0
    v_mov_b32 v231, 0
    v_dot2_f32_bf16 v228, v16, v16, v228
    v_dot2_f32_bf16 v229, v24, v24, v229
    v_dot2_f32_bf16 v230, v32, v32, v230
    v_dot2_f32_bf16 v231, v40, v40, v231
    v_dot2_f32_bf16 v228, v17, v17, v228
    v_dot2_f32_bf16 v229, v25, v25, v229
    v_dot2_f32_bf16 v230, v33, v33, v230
    v_dot2_f32_bf16 v231, v41, v41, v231
    v_dot2_f32_bf16 v228, v18, v18, v228
    v_dot2_f32_bf16 v229, v26, v26, v229
    v_dot2_f32_bf16 v230, v34, v34, v230
    v_dot2_f32_bf16 v231, v42, v42, v231
    v_dot2_f32_bf16 v228, v19, v19, v228
    v_dot2_f32_bf16 v229, v27, v27, v229
    v_dot2_f32_bf16 v230, v35, v35, v230
    v_dot2_f32_bf16 v231, v43, v43, v231
    v_dot2_f32_bf16 v228, v20, v20, v228
    v_dot2_f32_bf16 v229, v28, v28, v229
    v_dot2_f32_bf16 v230, v36, v36, v230
    v_dot2_f32_bf16 v231, v44, v44, v231
    v_dot2_f32_bf16 v228, v21, v21, v228
    v_dot2_f32_bf16 v229, v29, v29, v229
    v_dot2_f32_bf16 v230, v37, v37, v230
    v_dot2_f32_bf16 v231, v45, v45, v231
    v_mov_b32 v232, v228
    v_mov_b32 v233, v229
    v_mov_b32 v234, v230
    v_mov_b32 v235, v231
    v_permlane32_swap_b32 v228, v232
    v_permlane32_swap_b32 v229, v233
    v_permlane32_swap_b32 v230, v234
    v_permlane32_swap_b32 v231, v235
    v_add_f32 v228, v228, v232
    v_add_f32 v229, v229, v233
    v_add_f32 v230, v230, v234
    v_add_f32 v231, v231, v235
    v_max3_f32 v228, v228, v229, v230
    v_max_f32 v228, v228, v231
    v_mul_f32 v228, s64, v228
    v_mov_b32 v229, 0x45564925
    v_cmp_nle_f32 vcc, v228, v229
    s_cmp_gt_u32 s44, 0x67800000
    s_cbranch_scc1 ma_slow
    s_cbranch_vccnz ma_slow
    s_waitcnt vmcnt(12)
    v_mfma_f32_32x32x16_bf16 v[112:127], v[160:163], v[16:19], 0
    v_mfma_f32_32x32x16_bf16 v[112:127], v[164:167], v[20:23], v[112:127]
    s_mov_b32 s39, 8
    s_nop 10
.p2align 6
ma_loop:
    v_mfma_f32_32x32x16_bf16 v[128:143], v[160:163], v[24:27], 0
    v_exp_f32 v112, v112
    v_exp_f32 v113, v113
    v_exp_f32 v114, v114
    v_exp_f32 v115, v115
    v_exp_f32 v116, v116
    v_mfma_f32_32x32x16_bf16 v[128:143], v[164:167], v[28:31], v[128:143]
    v_exp_f32 v117, v117
    v_exp_f32 v118, v118
    v_exp_f32 v119, v119
    v_exp_f32 v120, v120
    v_cvt_pk_bf16_f32 v144, v112, v113
    v_cvt_pk_bf16_f32 v145, v114, v115
    v_mfma_f32_32x32x16_bf16 v[96:111], v[216:219], v[152:155], v[96:111]
    v_exp_f32 v121, v121
    v_exp_f32 v122, v122
    v_exp_f32 v123, v123
    v_exp_f32 v124, v124
    v_cvt_pk_bf16_f32 v146, v116, v117
    v_cvt_pk_bf16_f32 v147, v118, v119
    v_mfma_f32_32x32x16_bf16 v[96:111], v[220:223], v[156:159], v[96:111]
    v_exp_f32 v125, v125
    v_exp_f32 v126, v126
    v_exp_f32 v127, v127
    v_cvt_pk_bf16_f32 v148, v120, v121
    v_cvt_pk_bf16_f32 v149, v122, v123
    v_cvt_pk_bf16_f32 v150, v124, v125
    v_cvt_pk_bf16_f32 v151, v126, v127
    s_waitcnt vmcnt(10)
    v_mfma_f32_32x32x16_bf16 v[112:127], v[160:163], v[32:35], 0
    v_exp_f32 v128, v128
    v_exp_f32 v129, v129
    v_exp_f32 v130, v130
    v_exp_f32 v131, v131
    v_exp_f32 v132, v132
    v_mfma_f32_32x32x16_bf16 v[112:127], v[164:167], v[36:39], v[112:127]
    buffer_load_dwordx4 v[216:219], v6, s[28:31], s38 offen
    buffer_load_dwordx4 v[220:223], v6, s[28:31], s38 offen offset:672
    s_add_u32 s38, s38, 2624
    v_exp_f32 v133, v133
    v_exp_f32 v134, v134
    v_exp_f32 v135, v135
    v_exp_f32 v136, v136
    v_cvt_pk_bf16_f32 v152, v128, v129
    v_cvt_pk_bf16_f32 v153, v130, v131
    v_mfma_f32_32x32x16_bf16 v[48:63], v[192:195], v[144:147], v[48:63]
    v_exp_f32 v137, v137
    v_exp_f32 v138, v138
    v_exp_f32 v139, v139
    v_exp_f32 v140, v140
    v_cvt_pk_bf16_f32 v154, v132, v133
    v_cvt_pk_bf16_f32 v155, v134, v135
    v_mfma_f32_32x32x16_bf16 v[48:63], v[196:199], v[148:151], v[48:63]
    v_exp_f32 v141, v141
    v_exp_f32 v142, v142
    v_exp_f32 v143, v143
    v_cvt_pk_bf16_f32 v156, v136, v137
    v_cvt_pk_bf16_f32 v157, v138, v139
    v_cvt_pk_bf16_f32 v158, v140, v141
    v_cvt_pk_bf16_f32 v159, v142, v143
    v_mfma_f32_32x32x16_bf16 v[128:143], v[160:163], v[40:43], 0
    v_exp_f32 v112, v112
    v_exp_f32 v113, v113
    v_exp_f32 v114, v114
    v_exp_f32 v115, v115
    v_exp_f32 v116, v116
    v_mfma_f32_32x32x16_bf16 v[128:143], v[164:167], v[44:47], v[128:143]
    v_exp_f32 v117, v117
    v_exp_f32 v118, v118
    v_exp_f32 v119, v119
    v_exp_f32 v120, v120
    v_cvt_pk_bf16_f32 v144, v112, v113
    v_cvt_pk_bf16_f32 v145, v114, v115
    v_mfma_f32_32x32x16_bf16 v[64:79], v[192:195], v[152:155], v[64:79]
    v_exp_f32 v121, v121
    v_exp_f32 v122, v122
    v_exp_f32 v123, v123
    v_exp_f32 v124, v124
    v_cvt_pk_bf16_f32 v146, v116, v117
    v_cvt_pk_bf16_f32 v147, v118, v119
    v_mfma_f32_32x32x16_bf16 v[64:79], v[196:199], v[156:159], v[64:79]
    v_exp_f32 v125, v125
    v_exp_f32 v126, v126
    v_exp_f32 v127, v127
    v_cvt_pk_bf16_f32 v148, v120, v121
    v_cvt_pk_bf16_f32 v149, v122, v123
    v_cvt_pk_bf16_f32 v150, v124, v125
    v_cvt_pk_bf16_f32 v151, v126, v127
    s_waitcnt vmcnt(10)
    v_mfma_f32_32x32x16_bf16 v[112:127], v[168:171], v[16:19], 0
    v_exp_f32 v128, v128
    v_exp_f32 v129, v129
    v_exp_f32 v130, v130
    v_exp_f32 v131, v131
    v_exp_f32 v132, v132
    v_mfma_f32_32x32x16_bf16 v[112:127], v[172:175], v[20:23], v[112:127]
    buffer_load_dwordx4 v[160:163], v4, s[28:31], s37 offen
    buffer_load_dwordx2 v[164:165], v5, s[28:31], s37 offen
    s_add_u32 s37, s37, 2624
    v_exp_f32 v133, v133
    v_exp_f32 v134, v134
    v_exp_f32 v135, v135
    v_exp_f32 v136, v136
    v_cvt_pk_bf16_f32 v152, v128, v129
    v_cvt_pk_bf16_f32 v153, v130, v131
    v_mfma_f32_32x32x16_bf16 v[80:95], v[192:195], v[144:147], v[80:95]
    v_exp_f32 v137, v137
    v_exp_f32 v138, v138
    v_exp_f32 v139, v139
    v_exp_f32 v140, v140
    v_cvt_pk_bf16_f32 v154, v132, v133
    v_cvt_pk_bf16_f32 v155, v134, v135
    v_mfma_f32_32x32x16_bf16 v[80:95], v[196:199], v[148:151], v[80:95]
    v_exp_f32 v141, v141
    v_exp_f32 v142, v142
    v_exp_f32 v143, v143
    v_cvt_pk_bf16_f32 v156, v136, v137
    v_cvt_pk_bf16_f32 v157, v138, v139
    v_cvt_pk_bf16_f32 v158, v140, v141
    v_cvt_pk_bf16_f32 v159, v142, v143
    v_mfma_f32_32x32x16_bf16 v[128:143], v[168:171], v[24:27], 0
    v_exp_f32 v112, v112
    v_exp_f32 v113, v113
    v_exp_f32 v114, v114
    v_exp_f32 v115, v115
    v_exp_f32 v116, v116
    v_mfma_f32_32x32x16_bf16 v[128:143], v[172:175], v[28:31], v[128:143]
    v_exp_f32 v117, v117
    v_exp_f32 v118, v118
    v_exp_f32 v119, v119
    v_exp_f32 v120, v120
    v_cvt_pk_bf16_f32 v144, v112, v113
    v_cvt_pk_bf16_f32 v145, v114, v115
    v_mfma_f32_32x32x16_bf16 v[96:111], v[192:195], v[152:155], v[96:111]
    v_exp_f32 v121, v121
    v_exp_f32 v122, v122
    v_exp_f32 v123, v123
    v_exp_f32 v124, v124
    v_cvt_pk_bf16_f32 v146, v116, v117
    v_cvt_pk_bf16_f32 v147, v118, v119
    v_mfma_f32_32x32x16_bf16 v[96:111], v[196:199], v[156:159], v[96:111]
    v_exp_f32 v125, v125
    v_exp_f32 v126, v126
    v_exp_f32 v127, v127
    v_cvt_pk_bf16_f32 v148, v120, v121
    v_cvt_pk_bf16_f32 v149, v122, v123
    v_cvt_pk_bf16_f32 v150, v124, v125
    v_cvt_pk_bf16_f32 v151, v126, v127
    s_waitcnt vmcnt(10)
    v_mfma_f32_32x32x16_bf16 v[112:127], v[168:171], v[32:35], 0
    v_exp_f32 v128, v128
    v_exp_f32 v129, v129
    v_exp_f32 v130, v130
    v_exp_f32 v131, v131
    v_exp_f32 v132, v132
    v_mfma_f32_32x32x16_bf16 v[112:127], v[172:175], v[36:39], v[112:127]
    buffer_load_dwordx4 v[192:195], v6, s[28:31], s38 offen
    buffer_load_dwordx4 v[196:199], v6, s[28:31], s38 offen offset:672
    s_add_u32 s38, s38, 2624
    v_exp_f32 v133, v133
    v_exp_f32 v134, v134
    v_exp_f32 v135, v135
    v_exp_f32 v136, v136
    v_cvt_pk_bf16_f32 v152, v128, v129
    v_cvt_pk_bf16_f32 v153, v130, v131
    v_mfma_f32_32x32x16_bf16 v[48:63], v[200:203], v[144:147], v[48:63]
    v_exp_f32 v137, v137
    v_exp_f32 v138, v138
    v_exp_f32 v139, v139
    v_exp_f32 v140, v140
    v_cvt_pk_bf16_f32 v154, v132, v133
    v_cvt_pk_bf16_f32 v155, v134, v135
    v_mfma_f32_32x32x16_bf16 v[48:63], v[204:207], v[148:151], v[48:63]
    v_exp_f32 v141, v141
    v_exp_f32 v142, v142
    v_exp_f32 v143, v143
    v_cvt_pk_bf16_f32 v156, v136, v137
    v_cvt_pk_bf16_f32 v157, v138, v139
    v_cvt_pk_bf16_f32 v158, v140, v141
    v_cvt_pk_bf16_f32 v159, v142, v143
    v_mfma_f32_32x32x16_bf16 v[128:143], v[168:171], v[40:43], 0
    v_exp_f32 v112, v112
    v_exp_f32 v113, v113
    v_exp_f32 v114, v114
    v_exp_f32 v115, v115
    v_exp_f32 v116, v116
    v_mfma_f32_32x32x16_bf16 v[128:143], v[172:175], v[44:47], v[128:143]
    v_exp_f32 v117, v117
    v_exp_f32 v118, v118
    v_exp_f32 v119, v119
    v_exp_f32 v120, v120
    v_cvt_pk_bf16_f32 v144, v112, v113
    v_cvt_pk_bf16_f32 v145, v114, v115
    v_mfma_f32_32x32x16_bf16 v[64:79], v[200:203], v[152:155], v[64:79]
    v_exp_f32 v121, v121
    v_exp_f32 v122, v122
    v_exp_f32 v123, v123
    v_exp_f32 v124, v124
    v_cvt_pk_bf16_f32 v146, v116, v117
    v_cvt_pk_bf16_f32 v147, v118, v119
    v_mfma_f32_32x32x16_bf16 v[64:79], v[204:207], v[156:159], v[64:79]
    v_exp_f32 v125, v125
    v_exp_f32 v126, v126
    v_exp_f32 v127, v127
    v_cvt_pk_bf16_f32 v148, v120, v121
    v_cvt_pk_bf16_f32 v149, v122, v123
    v_cvt_pk_bf16_f32 v150, v124, v125
    v_cvt_pk_bf16_f32 v151, v126, v127
    s_waitcnt vmcnt(10)
    v_mfma_f32_32x32x16_bf16 v[112:127], v[176:179], v[16:19], 0
    v_exp_f32 v128, v128
    v_exp_f32 v129, v129
    v_exp_f32 v130, v130
    v_exp_f32 v131, v131
    v_exp_f32 v132, v132
    v_mfma_f32_32x32x16_bf16 v[112:127], v[180:183], v[20:23], v[112:127]
    buffer_load_dwordx4 v[168:171], v4, s[28:31], s37 offen
    buffer_load_dwordx2 v[172:173], v5, s[28:31], s37 offen
    s_add_u32 s37, s37, 2624
    v_exp_f32 v133, v133
    v_exp_f32 v134, v134
    v_exp_f32 v135, v135
    v_exp_f32 v136, v136
    v_cvt_pk_bf16_f32 v152, v128, v129
    v_cvt_pk_bf16_f32 v153, v130, v131
    v_mfma_f32_32x32x16_bf16 v[80:95], v[200:203], v[144:147], v[80:95]
    v_exp_f32 v137, v137
    v_exp_f32 v138, v138
    v_exp_f32 v139, v139
    v_exp_f32 v140, v140
    v_cvt_pk_bf16_f32 v154, v132, v133
    v_cvt_pk_bf16_f32 v155, v134, v135
    v_mfma_f32_32x32x16_bf16 v[80:95], v[204:207], v[148:151], v[80:95]
    v_exp_f32 v141, v141
    v_exp_f32 v142, v142
    v_exp_f32 v143, v143
    v_cvt_pk_bf16_f32 v156, v136, v137
    v_cvt_pk_bf16_f32 v157, v138, v139
    v_cvt_pk_bf16_f32 v158, v140, v141
    v_cvt_pk_bf16_f32 v159, v142, v143
    v_mfma_f32_32x32x16_bf16 v[128:143], v[176:179], v[24:27], 0
    v_exp_f32 v112, v112
    v_exp_f32 v113, v113
    v_exp_f32 v114, v114
    v_exp_f32 v115, v115
    v_exp_f32 v116, v116
    v_mfma_f32_32x32x16_bf16 v[128:143], v[180:183], v[28:31], v[128:143]
    v_exp_f32 v117, v117
    v_exp_f32 v118, v118
    v_exp_f32 v119, v119
    v_exp_f32 v120, v120
    v_cvt_pk_bf16_f32 v144, v112, v113
    v_cvt_pk_bf16_f32 v145, v114, v115
    v_mfma_f32_32x32x16_bf16 v[96:111], v[200:203], v[152:155], v[96:111]
    v_exp_f32 v121, v121
    v_exp_f32 v122, v122
    v_exp_f32 v123, v123
    v_exp_f32 v124, v124
    v_cvt_pk_bf16_f32 v146, v116, v117
    v_cvt_pk_bf16_f32 v147, v118, v119
    v_mfma_f32_32x32x16_bf16 v[96:111], v[204:207], v[156:159], v[96:111]
    v_exp_f32 v125, v125
    v_exp_f32 v126, v126
    v_exp_f32 v127, v127
    v_cvt_pk_bf16_f32 v148, v120, v121
    v_cvt_pk_bf16_f32 v149, v122, v123
    v_cvt_pk_bf16_f32 v150, v124, v125
    v_cvt_pk_bf16_f32 v151, v126, v127
    s_waitcnt vmcnt(10)
    v_mfma_f32_32x32x16_bf16 v[112:127], v[176:179], v[32:35], 0
    v_exp_f32 v128, v128
    v_exp_f32 v129, v129
    v_exp_f32 v130, v130
    v_exp_f32 v131, v131
    v_exp_f32 v132, v132
    v_mfma_f32_32x32x16_bf16 v[112:127], v[180:183], v[36:39], v[112:127]
    buffer_load_dwordx4 v[200:203], v6, s[28:31], s38 offen
    buffer_load_dwordx4 v[204:207], v6, s[28:31], s38 offen offset:672
    s_add_u32 s38, s38, 2624
    v_exp_f32 v133, v133
    v_exp_f32 v134, v134
    v_exp_f32 v135, v135
    v_exp_f32 v136, v136
    v_cvt_pk_bf16_f32 v152, v128, v129
    v_cvt_pk_bf16_f32 v153, v130, v131
    v_mfma_f32_32x32x16_bf16 v[48:63], v[208:211], v[144:147], v[48:63]
    v_exp_f32 v137, v137
    v_exp_f32 v138, v138
    v_exp_f32 v139, v139
    v_exp_f32 v140, v140
    v_cvt_pk_bf16_f32 v154, v132, v133
    v_cvt_pk_bf16_f32 v155, v134, v135
    v_mfma_f32_32x32x16_bf16 v[48:63], v[212:215], v[148:151], v[48:63]
    v_exp_f32 v141, v141
    v_exp_f32 v142, v142
    v_exp_f32 v143, v143
    v_cvt_pk_bf16_f32 v156, v136, v137
    v_cvt_pk_bf16_f32 v157, v138, v139
    v_cvt_pk_bf16_f32 v158, v140, v141
    v_cvt_pk_bf16_f32 v159, v142, v143
    v_mfma_f32_32x32x16_bf16 v[128:143], v[176:179], v[40:43], 0
    v_exp_f32 v112, v112
    v_exp_f32 v113, v113
    v_exp_f32 v114, v114
    v_exp_f32 v115, v115
    v_exp_f32 v116, v116
    v_mfma_f32_32x32x16_bf16 v[128:143], v[180:183], v[44:47], v[128:143]
    v_exp_f32 v117, v117
    v_exp_f32 v118, v118
    v_exp_f32 v119, v119
    v_exp_f32 v120, v120
    v_cvt_pk_bf16_f32 v144, v112, v113
    v_cvt_pk_bf16_f32 v145, v114, v115
    v_mfma_f32_32x32x16_bf16 v[64:79], v[208:211], v[152:155], v[64:79]
    v_exp_f32 v121, v121
    v_exp_f32 v122, v122
    v_exp_f32 v123, v123
    v_exp_f32 v124, v124
    v_cvt_pk_bf16_f32 v146, v116, v117
    v_cvt_pk_bf16_f32 v147, v118, v119
    v_mfma_f32_32x32x16_bf16 v[64:79], v[212:215], v[156:159], v[64:79]
    v_exp_f32 v125, v125
    v_exp_f32 v126, v126
    v_exp_f32 v127, v127
    v_cvt_pk_bf16_f32 v148, v120, v121
    v_cvt_pk_bf16_f32 v149, v122, v123
    v_cvt_pk_bf16_f32 v150, v124, v125
    v_cvt_pk_bf16_f32 v151, v126, v127
    s_waitcnt vmcnt(10)
    v_mfma_f32_32x32x16_bf16 v[112:127], v[184:187], v[16:19], 0
    v_exp_f32 v128, v128
    v_exp_f32 v129, v129
    v_exp_f32 v130, v130
    v_exp_f32 v131, v131
    v_exp_f32 v132, v132
    v_mfma_f32_32x32x16_bf16 v[112:127], v[188:191], v[20:23], v[112:127]
    buffer_load_dwordx4 v[176:179], v4, s[28:31], s37 offen
    buffer_load_dwordx2 v[180:181], v5, s[28:31], s37 offen
    s_add_u32 s37, s37, 2624
    v_exp_f32 v133, v133
    v_exp_f32 v134, v134
    v_exp_f32 v135, v135
    v_exp_f32 v136, v136
    v_cvt_pk_bf16_f32 v152, v128, v129
    v_cvt_pk_bf16_f32 v153, v130, v131
    v_mfma_f32_32x32x16_bf16 v[80:95], v[208:211], v[144:147], v[80:95]
    v_exp_f32 v137, v137
    v_exp_f32 v138, v138
    v_exp_f32 v139, v139
    v_exp_f32 v140, v140
    v_cvt_pk_bf16_f32 v154, v132, v133
    v_cvt_pk_bf16_f32 v155, v134, v135
    v_mfma_f32_32x32x16_bf16 v[80:95], v[212:215], v[148:151], v[80:95]
    v_exp_f32 v141, v141
    v_exp_f32 v142, v142
    v_exp_f32 v143, v143
    v_cvt_pk_bf16_f32 v156, v136, v137
    v_cvt_pk_bf16_f32 v157, v138, v139
    v_cvt_pk_bf16_f32 v158, v140, v141
    v_cvt_pk_bf16_f32 v159, v142, v143
    v_mfma_f32_32x32x16_bf16 v[128:143], v[184:187], v[24:27], 0
    v_exp_f32 v112, v112
    v_exp_f32 v113, v113
    v_exp_f32 v114, v114
    v_exp_f32 v115, v115
    v_exp_f32 v116, v116
    v_mfma_f32_32x32x16_bf16 v[128:143], v[188:191], v[28:31], v[128:143]
    v_exp_f32 v117, v117
    v_exp_f32 v118, v118
    v_exp_f32 v119, v119
    v_exp_f32 v120, v120
    v_cvt_pk_bf16_f32 v144, v112, v113
    v_cvt_pk_bf16_f32 v145, v114, v115
    v_mfma_f32_32x32x16_bf16 v[96:111], v[208:211], v[152:155], v[96:111]
    v_exp_f32 v121, v121
    v_exp_f32 v122, v122
    v_exp_f32 v123, v123
    v_exp_f32 v124, v124
    v_cvt_pk_bf16_f32 v146, v116, v117
    v_cvt_pk_bf16_f32 v147, v118, v119
    v_mfma_f32_32x32x16_bf16 v[96:111], v[212:215], v[156:159], v[96:111]
    v_exp_f32 v125, v125
    v_exp_f32 v126, v126
    v_exp_f32 v127, v127
    v_cvt_pk_bf16_f32 v148, v120, v121
    v_cvt_pk_bf16_f32 v149, v122, v123
    v_cvt_pk_bf16_f32 v150, v124, v125
    v_cvt_pk_bf16_f32 v151, v126, v127
    s_waitcnt vmcnt(10)
    v_mfma_f32_32x32x16_bf16 v[112:127], v[184:187], v[32:35], 0
    v_exp_f32 v128, v128
    v_exp_f32 v129, v129
    v_exp_f32 v130, v130
    v_exp_f32 v131, v131
    v_exp_f32 v132, v132
    v_mfma_f32_32x32x16_bf16 v[112:127], v[188:191], v[36:39], v[112:127]
    buffer_load_dwordx4 v[208:211], v6, s[28:31], s38 offen
    buffer_load_dwordx4 v[212:215], v6, s[28:31], s38 offen offset:672
    s_add_u32 s38, s38, 2624
    v_exp_f32 v133, v133
    v_exp_f32 v134, v134
    v_exp_f32 v135, v135
    v_exp_f32 v136, v136
    v_cvt_pk_bf16_f32 v152, v128, v129
    v_cvt_pk_bf16_f32 v153, v130, v131
    v_mfma_f32_32x32x16_bf16 v[48:63], v[216:219], v[144:147], v[48:63]
    v_exp_f32 v137, v137
    v_exp_f32 v138, v138
    v_exp_f32 v139, v139
    v_exp_f32 v140, v140
    v_cvt_pk_bf16_f32 v154, v132, v133
    v_cvt_pk_bf16_f32 v155, v134, v135
    v_mfma_f32_32x32x16_bf16 v[48:63], v[220:223], v[148:151], v[48:63]
    v_exp_f32 v141, v141
    v_exp_f32 v142, v142
    v_exp_f32 v143, v143
    v_cvt_pk_bf16_f32 v156, v136, v137
    v_cvt_pk_bf16_f32 v157, v138, v139
    v_cvt_pk_bf16_f32 v158, v140, v141
    v_cvt_pk_bf16_f32 v159, v142, v143
    v_mfma_f32_32x32x16_bf16 v[128:143], v[184:187], v[40:43], 0
    v_exp_f32 v112, v112
    v_exp_f32 v113, v113
    v_exp_f32 v114, v114
    v_exp_f32 v115, v115
    v_exp_f32 v116, v116
    v_mfma_f32_32x32x16_bf16 v[128:143], v[188:191], v[44:47], v[128:143]
    v_exp_f32 v117, v117
    v_exp_f32 v118, v118
    v_exp_f32 v119, v119
    v_exp_f32 v120, v120
    v_cvt_pk_bf16_f32 v144, v112, v113
    v_cvt_pk_bf16_f32 v145, v114, v115
    v_mfma_f32_32x32x16_bf16 v[64:79], v[216:219], v[152:155], v[64:79]
    v_exp_f32 v121, v121
    v_exp_f32 v122, v122
    v_exp_f32 v123, v123
    v_exp_f32 v124, v124
    v_cvt_pk_bf16_f32 v146, v116, v117
    v_cvt_pk_bf16_f32 v147, v118, v119
    v_mfma_f32_32x32x16_bf16 v[64:79], v[220:223], v[156:159], v[64:79]
    v_exp_f32 v125, v125
    v_exp_f32 v126, v126
    v_exp_f32 v127, v127
    v_cvt_pk_bf16_f32 v148, v120, v121
    v_cvt_pk_bf16_f32 v149, v122, v123
    v_cvt_pk_bf16_f32 v150, v124, v125
    v_cvt_pk_bf16_f32 v151, v126, v127
    s_waitcnt vmcnt(10)
    v_mfma_f32_32x32x16_bf16 v[112:127], v[160:163], v[16:19], 0
    v_exp_f32 v128, v128
    v_exp_f32 v129, v129
    v_exp_f32 v130, v130
    v_exp_f32 v131, v131
    v_exp_f32 v132, v132
    v_mfma_f32_32x32x16_bf16 v[112:127], v[164:167], v[20:23], v[112:127]
    buffer_load_dwordx4 v[184:187], v4, s[28:31], s37 offen
    buffer_load_dwordx2 v[188:189], v5, s[28:31], s37 offen
    s_add_u32 s37, s37, 2624
    v_exp_f32 v133, v133
    v_exp_f32 v134, v134
    v_exp_f32 v135, v135
    v_exp_f32 v136, v136
    v_cvt_pk_bf16_f32 v152, v128, v129
    v_cvt_pk_bf16_f32 v153, v130, v131
    v_mfma_f32_32x32x16_bf16 v[80:95], v[216:219], v[144:147], v[80:95]
    v_exp_f32 v137, v137
    v_exp_f32 v138, v138
    v_exp_f32 v139, v139
    v_exp_f32 v140, v140
    v_cvt_pk_bf16_f32 v154, v132, v133
    v_cvt_pk_bf16_f32 v155, v134, v135
    v_mfma_f32_32x32x16_bf16 v[80:95], v[220:223], v[148:151], v[80:95]
    v_exp_f32 v141, v141
    v_exp_f32 v142, v142
    v_exp_f32 v143, v143
    v_cvt_pk_bf16_f32 v156, v136, v137
    v_cvt_pk_bf16_f32 v157, v138, v139
    v_cvt_pk_bf16_f32 v158, v140, v141
    v_cvt_pk_bf16_f32 v159, v142, v143
    s_sub_u32 s39, s39, 1
    s_cmp_lg_u32 s39, 0
    s_cbranch_scc1 ma_loop
    v_mfma_f32_32x32x16_bf16 v[96:111], v[216:219], v[152:155], v[96:111]
    v_mfma_f32_32x32x16_bf16 v[96:111], v[220:223], v[156:159], v[96:111]
    s_branch ma_epi
ma_slow:
    v_mov_b32 v224, 0xf149f2ca
    v_mov_b32 v225, 0xf149f2ca
    v_mov_b32 v226, 0xf149f2ca
    v_mov_b32 v227, 0xf149f2ca
    s_mov_b32 s39, 32
    s_sub_u32 s37, s37, 7872
    s_sub_u32 s38, s38, 5248
ma_sloop:
    s_waitcnt vmcnt(0)
    v_mfma_f32_32x32x16_bf16 v[112:127], v[160:163], v[16:19], 0
    v_mfma_f32_32x32x16_bf16 v[112:127], v[164:167], v[20:23], v[112:127]
    s_nop 11
    v_max3_f32 v228, v112, v113, v114
    v_max3_f32 v228, v228, v115, v116
    v_max3_f32 v228, v228, v117, v118
    v_max3_f32 v228, v228, v119, v120
    v_max3_f32 v228, v228, v121, v122
    v_max3_f32 v228, v228, v123, v124
    v_max3_f32 v228, v228, v125, v126
    v_max_f32 v228, v228, v127
    v_mov_b32 v229, v228
    s_nop 1
    v_permlane32_swap_b32 v228, v229
    v_max3_f32 v228, v228, v229, v224
    v_sub_f32 v229, v224, v228
    v_exp_f32 v229, v229
    v_mov_b32 v224, v228
    v_sub_f32 v112, v112, v228
    v_exp_f32 v112, v112
    v_sub_f32 v113, v113, v228
    v_exp_f32 v113, v113
    v_sub_f32 v114, v114, v228
    v_exp_f32 v114, v114
    v_sub_f32 v115, v115, v228
    v_exp_f32 v115, v115
    v_sub_f32 v116, v116, v228
    v_exp_f32 v116, v116
    v_sub_f32 v117, v117, v228
    v_exp_f32 v117, v117
    v_sub_f32 v118, v118, v228
    v_exp_f32 v118, v118
    v_sub_f32 v119, v119, v228
    v_exp_f32 v119, v119
    v_sub_f32 v120, v120, v228
    v_exp_f32 v120, v120
    v_sub_f32 v121, v121, v228
    v_exp_f32 v121, v121
    v_sub_f32 v122, v122, v228
    v_exp_f32 v122, v122
    v_sub_f32 v123, v123, v228
    v_exp_f32 v123, v123
    v_sub_f32 v124, v124, v228
    v_exp_f32 v124, v124
    v_sub_f32 v125, v125, v228
    v_exp_f32 v125, v125
    v_sub_f32 v126, v126, v228
    v_exp_f32 v126, v126
    v_sub_f32 v127, v127, v228
    v_exp_f32 v127, v127
    v_cvt_pk_bf16_f32 v144, v112, v113
    v_cvt_pk_bf16_f32 v145, v114, v115
    v_cvt_pk_bf16_f32 v146, v116, v117
    v_cvt_pk_bf16_f32 v147, v118, v119
    v_cvt_pk_bf16_f32 v148, v120, v121
    v_cvt_pk_bf16_f32 v149, v122, v123
    v_cvt_pk_bf16_f32 v150, v124, v125
    v_cvt_pk_bf16_f32 v151, v126, v127
    v_mul_f32 v48, v48, v229
    v_mul_f32 v49, v49, v229
    v_mul_f32 v50, v50, v229
    v_mul_f32 v51, v51, v229
    v_mul_f32 v52, v52, v229
    v_mul_f32 v53, v53, v229
    v_mul_f32 v54, v54, v229
    v_mul_f32 v55, v55, v229
    v_mul_f32 v56, v56, v229
    v_mul_f32 v57, v57, v229
    v_mul_f32 v58, v58, v229
    v_mul_f32 v59, v59, v229
    v_mul_f32 v60, v60, v229
    v_mul_f32 v61, v61, v229
    v_mul_f32 v62, v62, v229
    v_mul_f32 v63, v63, v229
    s_nop 1
    v_mfma_f32_32x32x16_bf16 v[48:63], v[192:195], v[144:147], v[48:63]
    v_mfma_f32_32x32x16_bf16 v[48:63], v[196:199], v[148:151], v[48:63]
    v_mfma_f32_32x32x16_bf16 v[112:127], v[160:163], v[24:27], 0
    v_mfma_f32_32x32x16_bf16 v[112:127], v[164:167], v[28:31], v[112:127]
    s_nop 11
    v_max3_f32 v228, v112, v113, v114
    v_max3_f32 v228, v228, v115, v116
    v_max3_f32 v228, v228, v117, v118
    v_max3_f32 v228, v228, v119, v120
    v_max3_f32 v228, v228, v121, v122
    v_max3_f32 v228, v228, v123, v124
    v_max3_f32 v228, v228, v125, v126
    v_max_f32 v228, v228, v127
    v_mov_b32 v229, v228
    s_nop 1
    v_permlane32_swap_b32 v228, v229
    v_max3_f32 v228, v228, v229, v225
    v_sub_f32 v229, v225, v228
    v_exp_f32 v229, v229
    v_mov_b32 v225, v228
    v_sub_f32 v112, v112, v228
    v_exp_f32 v112, v112
    v_sub_f32 v113, v113, v228
    v_exp_f32 v113, v113
    v_sub_f32 v114, v114, v228
    v_exp_f32 v114, v114
    v_sub_f32 v115, v115, v228
    v_exp_f32 v115, v115
    v_sub_f32 v116, v116, v228
    v_exp_f32 v116, v116
    v_sub_f32 v117, v117, v228
    v_exp_f32 v117, v117
    v_sub_f32 v118, v118, v228
    v_exp_f32 v118, v118
    v_sub_f32 v119, v119, v228
    v_exp_f32 v119, v119
    v_sub_f32 v120, v120, v228
    v_exp_f32 v120, v120
    v_sub_f32 v121, v121, v228
    v_exp_f32 v121, v121
    v_sub_f32 v122, v122, v228
    v_exp_f32 v122, v122
    v_sub_f32 v123, v123, v228
    v_exp_f32 v123, v123
    v_sub_f32 v124, v124, v228
    v_exp_f32 v124, v124
    v_sub_f32 v125, v125, v228
    v_exp_f32 v125, v125
    v_sub_f32 v126, v126, v228
    v_exp_f32 v126, v126
    v_sub_f32 v127, v127, v228
    v_exp_f32 v127, v127
    v_cvt_pk_bf16_f32 v144, v112, v113
    v_cvt_pk_bf16_f32 v145, v114, v115
    v_cvt_pk_bf16_f32 v146, v116, v117
    v_cvt_pk_bf16_f32 v147, v118, v119
    v_cvt_pk_bf16_f32 v148, v120, v121
    v_cvt_pk_bf16_f32 v149, v122, v123
    v_cvt_pk_bf16_f32 v150, v124, v125
    v_cvt_pk_bf16_f32 v151, v126, v127
    v_mul_f32 v64, v64, v229
    v_mul_f32 v65, v65, v229
    v_mul_f32 v66, v66, v229
    v_mul_f32 v67, v67, v229
    v_mul_f32 v68, v68, v229
    v_mul_f32 v69, v69, v229
    v_mul_f32 v70, v70, v229
    v_mul_f32 v71, v71, v229
    v_mul_f32 v72, v72, v229
    v_mul_f32 v73, v73, v229
    v_mul_f32 v74, v74, v229
    v_mul_f32 v75, v75, v229
    v_mul_f32 v76, v76, v229
    v_mul_f32 v77, v77, v229
    v_mul_f32 v78, v78, v229
    v_mul_f32 v79, v79, v229
    s_nop 1
    v_mfma_f32_32x32x16_bf16 v[64:79], v[192:195], v[144:147], v[64:79]
    v_mfma_f32_32x32x16_bf16 v[64:79], v[196:199], v[148:151], v[64:79]
    v_mfma_f32_32x32x16_bf16 v[112:127], v[160:163], v[32:35], 0
    v_mfma_f32_32x32x16_bf16 v[112:127], v[164:167], v[36:39], v[112:127]
    s_nop 11
    v_max3_f32 v228, v112, v113, v114
    v_max3_f32 v228, v228, v115, v116
    v_max3_f32 v228, v228, v117, v118
    v_max3_f32 v228, v228, v119, v120
    v_max3_f32 v228, v228, v121, v122
    v_max3_f32 v228, v228, v123, v124
    v_max3_f32 v228, v228, v125, v126
    v_max_f32 v228, v228, v127
    v_mov_b32 v229, v228
    s_nop 1
    v_permlane32_swap_b32 v228, v229
    v_max3_f32 v228, v228, v229, v226
    v_sub_f32 v229, v226, v228
    v_exp_f32 v229, v229
    v_mov_b32 v226, v228
    v_sub_f32 v112, v112, v228
    v_exp_f32 v112, v112
    v_sub_f32 v113, v113, v228
    v_exp_f32 v113, v113
    v_sub_f32 v114, v114, v228
    v_exp_f32 v114, v114
    v_sub_f32 v115, v115, v228
    v_exp_f32 v115, v115
    v_sub_f32 v116, v116, v228
    v_exp_f32 v116, v116
    v_sub_f32 v117, v117, v228
    v_exp_f32 v117, v117
    v_sub_f32 v118, v118, v228
    v_exp_f32 v118, v118
    v_sub_f32 v119, v119, v228
    v_exp_f32 v119, v119
    v_sub_f32 v120, v120, v228
    v_exp_f32 v120, v120
    v_sub_f32 v121, v121, v228
    v_exp_f32 v121, v121
    v_sub_f32 v122, v122, v228
    v_exp_f32 v122, v122
    v_sub_f32 v123, v123, v228
    v_exp_f32 v123, v123
    v_sub_f32 v124, v124, v228
    v_exp_f32 v124, v124
    v_sub_f32 v125, v125, v228
    v_exp_f32 v125, v125
    v_sub_f32 v126, v126, v228
    v_exp_f32 v126, v126
    v_sub_f32 v127, v127, v228
    v_exp_f32 v127, v127
    v_cvt_pk_bf16_f32 v144, v112, v113
    v_cvt_pk_bf16_f32 v145, v114, v115
    v_cvt_pk_bf16_f32 v146, v116, v117
    v_cvt_pk_bf16_f32 v147, v118, v119
    v_cvt_pk_bf16_f32 v148, v120, v121
    v_cvt_pk_bf16_f32 v149, v122, v123
    v_cvt_pk_bf16_f32 v150, v124, v125
    v_cvt_pk_bf16_f32 v151, v126, v127
    v_mul_f32 v80, v80, v229
    v_mul_f32 v81, v81, v229
    v_mul_f32 v82, v82, v229
    v_mul_f32 v83, v83, v229
    v_mul_f32 v84, v84, v229
    v_mul_f32 v85, v85, v229
    v_mul_f32 v86, v86, v229
    v_mul_f32 v87, v87, v229
    v_mul_f32 v88, v88, v229
    v_mul_f32 v89, v89, v229
    v_mul_f32 v90, v90, v229
    v_mul_f32 v91, v91, v229
    v_mul_f32 v92, v92, v229
    v_mul_f32 v93, v93, v229
    v_mul_f32 v94, v94, v229
    v_mul_f32 v95, v95, v229
    s_nop 1
    v_mfma_f32_32x32x16_bf16 v[80:95], v[192:195], v[144:147], v[80:95]
    v_mfma_f32_32x32x16_bf16 v[80:95], v[196:199], v[148:151], v[80:95]
    v_mfma_f32_32x32x16_bf16 v[112:127], v[160:163], v[40:43], 0
    v_mfma_f32_32x32x16_bf16 v[112:127], v[164:167], v[44:47], v[112:127]
    s_nop 11
    v_max3_f32 v228, v112, v113, v114
    v_max3_f32 v228, v228, v115, v116
    v_max3_f32 v228, v228, v117, v118
    v_max3_f32 v228, v228, v119, v120
    v_max3_f32 v228, v228, v121, v122
    v_max3_f32 v228, v228, v123, v124
    v_max3_f32 v228, v228, v125, v126
    v_max_f32 v228, v228, v127
    v_mov_b32 v229, v228
    s_nop 1
    v_permlane32_swap_b32 v228, v229
    v_max3_f32 v228, v228, v229, v227
    v_sub_f32 v229, v227, v228
    v_exp_f32 v229, v229
    v_mov_b32 v227, v228
    v_sub_f32 v112, v112, v228
    v_exp_f32 v112, v112
    v_sub_f32 v113, v113, v228
    v_exp_f32 v113, v113
    v_sub_f32 v114, v114, v228
    v_exp_f32 v114, v114
    v_sub_f32 v115, v115, v228
    v_exp_f32 v115, v115
    v_sub_f32 v116, v116, v228
    v_exp_f32 v116, v116
    v_sub_f32 v117, v117, v228
    v_exp_f32 v117, v117
    v_sub_f32 v118, v118, v228
    v_exp_f32 v118, v118
    v_sub_f32 v119, v119, v228
    v_exp_f32 v119, v119
    v_sub_f32 v120, v120, v228
    v_exp_f32 v120, v120
    v_sub_f32 v121, v121, v228
    v_exp_f32 v121, v121
    v_sub_f32 v122, v122, v228
    v_exp_f32 v122, v122
    v_sub_f32 v123, v123, v228
    v_exp_f32 v123, v123
    v_sub_f32 v124, v124, v228
    v_exp_f32 v124, v124
    v_sub_f32 v125, v125, v228
    v_exp_f32 v125, v125
    v_sub_f32 v126, v126, v228
    v_exp_f32 v126, v126
    v_sub_f32 v127, v127, v228
    v_exp_f32 v127, v127
    v_cvt_pk_bf16_f32 v144, v112, v113
    v_cvt_pk_bf16_f32 v145, v114, v115
    v_cvt_pk_bf16_f32 v146, v116, v117
    v_cvt_pk_bf16_f32 v147, v118, v119
    v_cvt_pk_bf16_f32 v148, v120, v121
    v_cvt_pk_bf16_f32 v149, v122, v123
    v_cvt_pk_bf16_f32 v150, v124, v125
    v_cvt_pk_bf16_f32 v151, v126, v127
    v_mul_f32 v96, v96, v229
    v_mul_f32 v97, v97, v229
    v_mul_f32 v98, v98, v229
    v_mul_f32 v99, v99, v229
    v_mul_f32 v100, v100, v229
    v_mul_f32 v101, v101, v229
    v_mul_f32 v102, v102, v229
    v_mul_f32 v103, v103, v229
    v_mul_f32 v104, v104, v229
    v_mul_f32 v105, v105, v229
    v_mul_f32 v106, v106, v229
    v_mul_f32 v107, v107, v229
    v_mul_f32 v108, v108, v229
    v_mul_f32 v109, v109, v229
    v_mul_f32 v110, v110, v229
    v_mul_f32 v111, v111, v229
    s_nop 1
    v_mfma_f32_32x32x16_bf16 v[96:111], v[192:195], v[144:147], v[96:111]
    v_mfma_f32_32x32x16_bf16 v[96:111], v[196:199], v[148:151], v[96:111]
    buffer_load_dwordx4 v[160:163], v4, s[28:31], s37 offen
    buffer_load_dwordx2 v[164:165], v5, s[28:31], s37 offen
    s_add_u32 s37, s37, 2624
    buffer_load_dwordx4 v[192:195], v6, s[28:31], s38 offen
    buffer_load_dwordx4 v[196:199], v6, s[28:31], s38 offen offset:672
    s_add_u32 s38, s38, 2624
    s_sub_u32 s39, s39, 1
    s_cmp_lg_u32 s39, 0
    s_cbranch_scc1 ma_sloop
ma_epi:
    s_waitcnt vmcnt(0)
    s_mul_i32 s40, s32, 6656
    s_xor_b32 s41, s32, 1
    s_mul_i32 s41, s41, 6656
    v_add_u32 v228, s40, v4
    v_add_u32 v229, s41, v4
    v_lshlrev_b32 v230, 2, v1
    v_add_u32 v231, s41, v230
    v_add_u32 v230, s40, v230
    s_cmp_eq_u32 s34, 0
    s_cbranch_scc1 ma_e0
    ds_write_b128 v228, v[48:51] offset:0
    ds_write_b128 v228, v[52:55] offset:1024
    ds_write_b128 v228, v[56:59] offset:2048
    ds_write_b32 v230, v224 offset:6144
    ds_write_b128 v228, v[64:67] offset:3072
    ds_write_b128 v228, v[68:71] offset:4096
    ds_write_b128 v228, v[72:75] offset:5120
    ds_write_b32 v230, v225 offset:6400
    s_waitcnt lgkmcnt(0)
    v_mov_b32 v48, v80
    v_mov_b32 v49, v81
    v_mov_b32 v50, v82
    v_mov_b32 v51, v83
    v_mov_b32 v52, v84
    v_mov_b32 v53, v85
    v_mov_b32 v54, v86
    v_mov_b32 v55, v87
    v_mov_b32 v56, v88
    v_mov_b32 v57, v89
    v_mov_b32 v58, v90
    v_mov_b32 v59, v91
    v_mov_b32 v224, v226
    v_mov_b32 v64, v96
    v_mov_b32 v65, v97
    v_mov_b32 v66, v98
    v_mov_b32 v67, v99
    v_mov_b32 v68, v100
    v_mov_b32 v69, v101
    v_mov_b32 v70, v102
    v_mov_b32 v71, v103
    v_mov_b32 v72, v104
    v_mov_b32 v73, v105
    v_mov_b32 v74, v106
    v_mov_b32 v75, v107
    v_mov_b32 v225, v227
    s_add_u32 s35, s35, 2
    s_branch ma_e1
ma_e0:
    ds_write_b128 v228, v[80:83] offset:0
    ds_write_b128 v228, v[84:87] offset:1024
    ds_write_b128 v228, v[88:91] offset:2048
    ds_write_b32 v230, v226 offset:6144
    ds_write_b128 v228, v[96:99] offset:3072
    ds_write_b128 v228, v[100:103] offset:4096
    ds_write_b128 v228, v[104:107] offset:5120
    ds_write_b32 v230, v227 offset:6400
    s_waitcnt lgkmcnt(0)
ma_e1:
    s_barrier
    ds_read_b128 v[112:115], v229 offset:0
    ds_read_b128 v[116:119], v229 offset:1024
    ds_read_b128 v[120:123], v229 offset:2048
    ds_read_b32 v226, v231 offset:6144
    ds_read_b128 v[128:131], v229 offset:3072
    ds_read_b128 v[132:135], v229 offset:4096
    ds_read_b128 v[136:139], v229 offset:5120
    ds_read_b32 v227, v231 offset:6400
    s_waitcnt lgkmcnt(0)
    s_mul_i32 s40, s33, 40960
    s_add_u32 s40, s40, 5439488
    v_mov_b32 v240, 0x80000000
    v_cmp_eq_u32 s[42:43], 0, v3
    v_max_f32 v232, v224, v226
    v_sub_f32 v233, v224, v232
    v_sub_f32 v234, v226, v232
    v_exp_f32 v233, v233
    v_exp_f32 v234, v234
    v_mul_f32 v48, v48, v233
    v_fmac_f32 v48, v112, v234
    v_mul_f32 v49, v49, v233
    v_fmac_f32 v49, v113, v234
    v_mul_f32 v50, v50, v233
    v_fmac_f32 v50, v114, v234
    v_mul_f32 v51, v51, v233
    v_fmac_f32 v51, v115, v234
    v_mul_f32 v52, v52, v233
    v_fmac_f32 v52, v116, v234
    v_mul_f32 v53, v53, v233
    v_fmac_f32 v53, v117, v234
    v_mul_f32 v54, v54, v233
    v_fmac_f32 v54, v118, v234
    v_mul_f32 v55, v55, v233
    v_fmac_f32 v55, v119, v234
    v_mul_f32 v56, v56, v233
    v_fmac_f32 v56, v120, v234
    v_mul_f32 v57, v57, v233
    v_fmac_f32 v57, v121, v234
    v_mul_f32 v58, v58, v233
    v_fmac_f32 v58, v122, v234
    v_mul_f32 v59, v59, v233
    v_fmac_f32 v59, v123, v234
    v_mov_b32 v235, v56
    v_mov_b32 v236, v56
    s_nop 1
    v_permlane32_swap_b32 v235, v236
    v_rcp_f32 v236, v236
    s_nop 0
    v_mul_f32 v48, v48, v236
    v_mul_f32 v49, v49, v236
    v_mul_f32 v50, v50, v236
    v_mul_f32 v51, v51, v236
    v_mul_f32 v52, v52, v236
    v_mul_f32 v53, v53, v236
    v_mul_f32 v54, v54, v236
    v_mul_f32 v55, v55, v236
    v_mul_f32 v56, v56, v236
    v_mul_f32 v57, v57, v236
    v_mul_f32 v58, v58, v236
    v_mul_f32 v59, v59, v236
    v_cvt_pk_bf16_f32 v48, v48, v49
    v_cvt_pk_bf16_f32 v49, v50, v51
    v_cvt_pk_bf16_f32 v52, v52, v53
    v_cvt_pk_bf16_f32 v53, v54, v55
    v_cvt_pk_bf16_f32 v56, v56, v57
    v_cvt_pk_bf16_f32 v57, v58, v59
    s_add_u32 s41, s35, 0
    s_mul_i32 s41, s41, 20
    v_lshlrev_b32 v237, 2, v3
    v_add_u32 v237, s41, v237
    v_lshrrev_b32 v238, 4, v237
    v_lshlrev_b32 v238, 10, v238
    v_lshl_add_u32 v238, v2, 4, v238
    v_and_b32 v239, 4, v237
    v_lshl_add_u32 v238, v239, 7, v238
    v_and_b32 v237, 8, v237
    v_add_u32 v238, v237, v238
    buffer_store_dwordx2 v[48:49], v238, s[28:31], s40 offen sc1
    v_lshlrev_b32 v237, 2, v3
    v_add_u32 v237, s41, v237
    v_add_u32 v237, 8, v237
    v_lshrrev_b32 v238, 4, v237
    v_lshlrev_b32 v238, 10, v238
    v_lshl_add_u32 v238, v2, 4, v238
    v_and_b32 v239, 4, v237
    v_lshl_add_u32 v238, v239, 7, v238
    v_and_b32 v237, 8, v237
    v_add_u32 v238, v237, v238
    buffer_store_dwordx2 v[52:53], v238, s[28:31], s40 offen sc1
    v_lshlrev_b32 v237, 2, v3
    v_add_u32 v237, s41, v237
    v_add_u32 v237, 16, v237
    v_lshrrev_b32 v238, 4, v237
    v_lshlrev_b32 v238, 10, v238
    v_lshl_add_u32 v238, v2, 4, v238
    v_and_b32 v239, 4, v237
    v_lshl_add_u32 v238, v239, 7, v238
    v_and_b32 v237, 8, v237
    v_add_u32 v238, v237, v238
    v_cndmask_b32 v238, v240, v238, s[42:43]
    buffer_store_dwordx2 v[56:57], v238, s[28:31], s40 offen sc1
    v_max_f32 v232, v225, v227
    v_sub_f32 v233, v225, v232
    v_sub_f32 v234, v227, v232
    v_exp_f32 v233, v233
    v_exp_f32 v234, v234
    v_mul_f32 v64, v64, v233
    v_fmac_f32 v64, v128, v234
    v_mul_f32 v65, v65, v233
    v_fmac_f32 v65, v129, v234
    v_mul_f32 v66, v66, v233
    v_fmac_f32 v66, v130, v234
    v_mul_f32 v67, v67, v233
    v_fmac_f32 v67, v131, v234
    v_mul_f32 v68, v68, v233
    v_fmac_f32 v68, v132, v234
    v_mul_f32 v69, v69, v233
    v_fmac_f32 v69, v133, v234
    v_mul_f32 v70, v70, v233
    v_fmac_f32 v70, v134, v234
    v_mul_f32 v71, v71, v233
    v_fmac_f32 v71, v135, v234
    v_mul_f32 v72, v72, v233
    v_fmac_f32 v72, v136, v234
    v_mul_f32 v73, v73, v233
    v_fmac_f32 v73, v137, v234
    v_mul_f32 v74, v74, v233
    v_fmac_f32 v74, v138, v234
    v_mul_f32 v75, v75, v233
    v_fmac_f32 v75, v139, v234
    v_mov_b32 v235, v72
    v_mov_b32 v236, v72
    s_nop 1
    v_permlane32_swap_b32 v235, v236
    v_rcp_f32 v236, v236
    s_nop 0
    v_mul_f32 v64, v64, v236
    v_mul_f32 v65, v65, v236
    v_mul_f32 v66, v66, v236
    v_mul_f32 v67, v67, v236
    v_mul_f32 v68, v68, v236
    v_mul_f32 v69, v69, v236
    v_mul_f32 v70, v70, v236
    v_mul_f32 v71, v71, v236
    v_mul_f32 v72, v72, v236
    v_mul_f32 v73, v73, v236
    v_mul_f32 v74, v74, v236
    v_mul_f32 v75, v75, v236
    v_cvt_pk_bf16_f32 v64, v64, v65
    v_cvt_pk_bf16_f32 v65, v66, v67
    v_cvt_pk_bf16_f32 v68, v68, v69
    v_cvt_pk_bf16_f32 v69, v70, v71
    v_cvt_pk_bf16_f32 v72, v72, v73
    v_cvt_pk_bf16_f32 v73, v74, v75
    s_add_u32 s41, s35, 1
    s_mul_i32 s41, s41, 20
    v_lshlrev_b32 v237, 2, v3
    v_add_u32 v237, s41, v237
    v_lshrrev_b32 v238, 4, v237
    v_lshlrev_b32 v238, 10, v238
    v_lshl_add_u32 v238, v2, 4, v238
    v_and_b32 v239, 4, v237
    v_lshl_add_u32 v238, v239, 7, v238
    v_and_b32 v237, 8, v237
    v_add_u32 v238, v237, v238
    buffer_store_dwordx2 v[64:65], v238, s[28:31], s40 offen sc1
    v_lshlrev_b32 v237, 2, v3
    v_add_u32 v237, s41, v237
    v_add_u32 v237, 8, v237
    v_lshrrev_b32 v238, 4, v237
    v_lshlrev_b32 v238, 10, v238
    v_lshl_add_u32 v238, v2, 4, v238
    v_and_b32 v239, 4, v237
    v_lshl_add_u32 v238, v239, 7, v238
    v_and_b32 v237, 8, v237
    v_add_u32 v238, v237, v238
    buffer_store_dwordx2 v[68:69], v238, s[28:31], s40 offen sc1
    v_lshlrev_b32 v237, 2, v3
    v_add_u32 v237, s41, v237
    v_add_u32 v237, 16, v237
    v_lshrrev_b32 v238, 4, v237
    v_lshlrev_b32 v238, 10, v238
    v_lshl_add_u32 v238, v2, 4, v238
    v_and_b32 v239, 4, v237
    v_lshl_add_u32 v238, v239, 7, v238
    v_and_b32 v237, 8, v237
    v_add_u32 v238, v237, v238
    v_cndmask_b32 v238, v240, v238, s[42:43]
    buffer_store_dwordx2 v[72:73], v238, s[28:31], s40 offen sc1
    s_waitcnt vmcnt(0)
    s_barrier
    s_cmp_lg_u32 s32, 0
    s_cbranch_scc1 ma_nosig
    s_lshr_b32 s40, s33, 1
    s_lshl_b32 s40, s40, 8
    s_add_u32 s40, s40, 5427200
    v_mov_b32 v228, 0
    v_mov_b32 v229, 1
    s_mov_b64 exec, 1
    buffer_atomic_add v229, v228, s[28:31], s40 offen sc1
    s_mov_b64 exec, -1
ma_nosig:
    s_endpgm
main_ffn:
    s_sub_u32 s69, s2, 256
    s_load_dwordx2 s[8:9], s[0:1], 64
    s_load_dwordx2 s[14:15], s[0:1], 0
    s_load_dwordx2 s[84:85], s[0:1], 32
    s_load_dwordx2 s[86:87], s[0:1], 72
    s_load_dwordx2 s[12:13], s[0:1], 88
    v_and_b32 v1, 63, v0
    v_lshrrev_b32 v224, 6, v0
    s_nop 0
    v_readfirstlane_b32 s32, v224
    v_and_b32 v2, 31, v0
    v_bfe_u32 v3, v0, 5, 1
    v_lshlrev_b32 v5, 4, v1
    s_and_b32 s3, s69, 7
    s_lshl_b32 s3, s3, 2
    s_bfe_u32 s36, s69, 0x20003
    s_add_u32 s63, s3, s36
    s_lshr_b32 s64, s69, 5
    v_lshrrev_b32 v224, 2, v1
    v_mul_u32_u24 v8, 1280, v224
    v_and_b32 v224, 3, v1
    v_lshl_add_u32 v8, v224, 4, v8
    v_lshlrev_b32 v9, 8, v3
    v_bfe_u32 v224, v1, 2, 2
    v_lshl_add_u32 v9, v224, 6, v9
    v_bfe_u32 v224, v1, 4, 1
    v_lshl_add_u32 v9, v224, 5, v9
    v_and_b32 v224, 3, v1
    v_lshl_add_u32 v9, v224, 3, v9
    s_mul_i32 s67, s32, 18432
    v_add_u32 v9, s67, v9
    v_mul_u32_u24 v10, 1280, v2
    v_lshl_add_u32 v10, v3, 3, v10
    s_mul_i32 s66, s32, 491520
    s_mul_i32 s37, s64, 192
    s_add_u32 s66, s66, s37
    s_mul_i32 s68, s63, 196608
    s_mul_i32 s36, s32, 24576
    s_add_u32 s68, s68, s36
    s_add_u32 s68, s68, 8388608
    s_add_u32 s65, s68, 98304
    s_mul_i32 s70, s63, 81920
    s_add_u32 s70, s70, s37
    s_and_b32 s36, s32, 1
    s_mul_i32 s36, s36, 40960
    s_add_u32 s70, s70, s36
    s_lshr_b32 s36, s32, 1
    s_lshl_b32 s36, s36, 5
    s_add_u32 s70, s70, s36
    s_mul_i32 s88, s32, 204800
    s_add_u32 s88, s88, s37
    s_mul_i32 s89, s63, 81920
    s_mul_i32 s36, s32, 10240
    s_add_u32 s89, s89, s36
    s_add_u32 s89, s89, 5439488
    s_add_u32 s90, s89, 40960
    s_waitcnt lgkmcnt(0)
    s_mov_b32 s24, s8
    s_and_b32 s25, s9, 0xffff
    s_mov_b32 s26, 0x1e0000
    s_mov_b32 s27, 0x00020000
    s_mov_b32 s76, s14
    s_and_b32 s77, s15, 0xffff
    s_mov_b32 s78, 0x280000
    s_mov_b32 s79, 0x00020000
    s_mov_b32 s28, s12
    s_and_b32 s29, s13, 0xffff
    s_mov_b32 s30, 0x2500000
    s_mov_b32 s31, 0x00020000
    s_mov_b32 s80, s84
    s_and_b32 s81, s85, 0xffff
    s_mov_b32 s82, 0xc8000
    s_mov_b32 s83, 0x00020000
    s_mov_b32 s84, s86
    s_and_b32 s85, s87, 0xffff
    s_mov_b32 s86, 0x280000
    s_mov_b32 s87, 0x00020000
    s_lshr_b32 s96, s69, 3
    s_lshl_b32 s96, s96, 2
    s_add_u32 s96, s96, s32
    s_lshl_b32 s96, s96, 14
    v_lshlrev_b32 v11, 6, v1
    s_load_dwordx4 s[4:7], s[0:1], 48
    s_load_dwordx2 s[12:13], s[0:1], 88
    v_and_b32 v1, 63, v0
    v_lshrrev_b32 v208, 6, v0
    s_nop 0
    v_readfirstlane_b32 s32, v208
    v_and_b32 v2, 31, v0
    v_bfe_u32 v3, v0, 5, 1
    s_and_b32 s3, s69, 7
    s_lshr_b32 s35, s69, 3
    s_and_b32 s36, s3, 1
    s_lshl_b32 s36, s36, 3
    s_and_b32 s37, s35, 7
    s_add_u32 s33, s36, s37
    s_lshr_b32 s36, s3, 1
    s_lshl_b32 s36, s36, 2
    s_lshr_b32 s37, s35, 3
    s_add_u32 s34, s36, s37
    v_lshrrev_b32 v208, 2, v1
    v_mul_u32_u24 v4, 3072, v208
    v_and_b32 v208, 3, v1
    v_lshl_add_u32 v4, v208, 4, v4
    v_lshlrev_b32 v6, 9, v3
    v_bfe_u32 v208, v1, 2, 2
    v_lshl_add_u32 v6, v208, 6, v6
    v_bfe_u32 v208, v1, 4, 1
    v_lshl_add_u32 v6, v208, 5, v6
    v_and_b32 v208, 3, v1
    v_lshl_add_u32 v6, v208, 3, v6
    v_lshlrev_b32 v5, 4, v1
    s_mul_i32 s40, s32, 49152
    s_mul_i32 s41, s34, 192
    s_add_u32 s40, s40, s41
    s_lshl_b32 s42, s33, 2
    s_add_u32 s42, s42, s32
    s_mul_i32 s43, s42, 40960
    s_waitcnt lgkmcnt(0)
    s_mov_b32 s16, s4
    s_and_b32 s17, s5, 0xffff
    s_mov_b32 s18, 0x1e0000
    s_mov_b32 s19, 0x00020000
    s_mov_b32 s20, s6
    s_and_b32 s21, s7, 0xffff
    s_mov_b32 s22, 0x1e0000
    s_mov_b32 s23, 0x00020000
    s_mov_b32 s28, s12
    s_and_b32 s29, s13, 0xffff
    s_mov_b32 s30, 0x2500000
    s_mov_b32 s31, 0x00020000
    s_mul_i32 s60, s32, 6144
    v_add_u32 v7, 49152, v6
    s_add_u32 m0, s60, 0
    s_add_u32 s61, s40, 0
    buffer_load_dwordx4 v4, s[16:19], s61 offen lds
    s_add_u32 m0, s60, 1024
    s_add_u32 s61, s40, 64
    buffer_load_dwordx4 v4, s[16:19], s61 offen lds
    s_add_u32 s62, s43, 0
    buffer_load_dwordx4 v[160:163], v5, s[28:31], s62 offen offset:0
    s_add_u32 m0, s60, 2048
    s_add_u32 s61, s40, 128
    buffer_load_dwordx4 v4, s[16:19], s61 offen lds
    buffer_load_dwordx4 v[164:167], v5, s[28:31], s62 offen offset:1024
    s_add_u32 m0, s60, 3072
    s_add_u32 s61, s40, 0
    buffer_load_dwordx4 v4, s[20:23], s61 offen lds
    buffer_load_dwordx4 v[168:171], v5, s[28:31], s62 offen offset:2048
    s_add_u32 m0, s60, 4096
    s_add_u32 s61, s40, 64
    buffer_load_dwordx4 v4, s[20:23], s61 offen lds
    buffer_load_dwordx4 v[172:175], v5, s[28:31], s62 offen offset:3072
    s_add_u32 m0, s60, 5120
    s_add_u32 s61, s40, 128
    buffer_load_dwordx4 v4, s[20:23], s61 offen lds
    s_add_u32 m0, s60, 24576
    s_add_u32 s61, s40, 196608
    buffer_load_dwordx4 v4, s[16:19], s61 offen lds
    s_add_u32 m0, s60, 25600
    s_add_u32 s61, s40, 196672
    buffer_load_dwordx4 v4, s[16:19], s61 offen lds
    s_add_u32 s62, s43, 4096
    buffer_load_dwordx4 v[176:179], v5, s[28:31], s62 offen offset:0
    s_add_u32 m0, s60, 26624
    s_add_u32 s61, s40, 196736
    buffer_load_dwordx4 v4, s[16:19], s61 offen lds
    buffer_load_dwordx4 v[180:183], v5, s[28:31], s62 offen offset:1024
    s_add_u32 m0, s60, 27648
    s_add_u32 s61, s40, 196608
    buffer_load_dwordx4 v4, s[20:23], s61 offen lds
    buffer_load_dwordx4 v[184:187], v5, s[28:31], s62 offen offset:2048
    s_add_u32 m0, s60, 28672
    s_add_u32 s61, s40, 196672
    buffer_load_dwordx4 v4, s[20:23], s61 offen lds
    buffer_load_dwordx4 v[188:191], v5, s[28:31], s62 offen offset:3072
    s_add_u32 m0, s60, 29696
    s_add_u32 s61, s40, 196736
    buffer_load_dwordx4 v4, s[20:23], s61 offen lds
    s_waitcnt vmcnt(10)
    s_barrier
    ds_read_b64_tr_b16 v[112:113], v6 offset:0
    ds_read_b64_tr_b16 v[114:115], v6 offset:256
    ds_read_b64_tr_b16 v[116:117], v6 offset:1024
    ds_read_b64_tr_b16 v[118:119], v6 offset:1280
    ds_read_b64_tr_b16 v[120:121], v6 offset:2048
    ds_read_b64_tr_b16 v[122:123], v6 offset:2304
    ds_read_b64_tr_b16 v[124:125], v6 offset:3072
    ds_read_b64_tr_b16 v[126:127], v6 offset:3328
    ds_read_b64_tr_b16 v[128:129], v6 offset:4096
    ds_read_b64_tr_b16 v[130:131], v6 offset:4352
    ds_read_b64_tr_b16 v[132:133], v6 offset:5120
    ds_read_b64_tr_b16 v[134:135], v6 offset:5376
    s_waitcnt lgkmcnt(10)
    v_mfma_f32_32x32x16_bf16 v[16:31], v[112:115], v[160:163], 0
    ds_read_b64_tr_b16 v[136:137], v6 offset:6144
    ds_read_b64_tr_b16 v[138:139], v6 offset:6400
    s_add_u32 m0, s60, 49152
    s_add_u32 s61, s40, 393216
    buffer_load_dwordx4 v4, s[16:19], s61 offen lds
    s_waitcnt lgkmcnt(10)
    v_mfma_f32_32x32x16_bf16 v[32:47], v[116:119], v[160:163], 0
    ds_read_b64_tr_b16 v[140:141], v6 offset:7168
    ds_read_b64_tr_b16 v[142:143], v6 offset:7424
    s_add_u32 m0, s60, 50176
    s_add_u32 s61, s40, 393280
    buffer_load_dwordx4 v4, s[16:19], s61 offen lds
    s_waitcnt lgkmcnt(10)
    v_mfma_f32_32x32x16_bf16 v[48:63], v[120:123], v[160:163], 0
    ds_read_b64_tr_b16 v[144:145], v6 offset:8192
    ds_read_b64_tr_b16 v[146:147], v6 offset:8448
    s_waitcnt lgkmcnt(10)
    v_mfma_f32_32x32x16_bf16 v[64:79], v[124:127], v[160:163], 0
    ds_read_b64_tr_b16 v[148:149], v6 offset:9216
    ds_read_b64_tr_b16 v[150:151], v6 offset:9472
    s_add_u32 s62, s43, 8192
    buffer_load_dwordx4 v[192:195], v5, s[28:31], s62 offen offset:0
    s_waitcnt lgkmcnt(10)
    v_mfma_f32_32x32x16_bf16 v[80:95], v[128:131], v[160:163], 0
    ds_read_b64_tr_b16 v[152:153], v6 offset:10240
    ds_read_b64_tr_b16 v[154:155], v6 offset:10496
    s_waitcnt lgkmcnt(10)
    v_mfma_f32_32x32x16_bf16 v[96:111], v[132:135], v[160:163], 0
    ds_read_b64_tr_b16 v[156:157], v6 offset:11264
    ds_read_b64_tr_b16 v[158:159], v6 offset:11520
    s_add_u32 m0, s60, 51200
    s_add_u32 s61, s40, 393344
    buffer_load_dwordx4 v4, s[16:19], s61 offen lds
    s_waitcnt lgkmcnt(10)
    v_mfma_f32_32x32x16_bf16 v[16:31], v[136:139], v[164:167], v[16:31]
    ds_read_b64_tr_b16 v[112:113], v6 offset:12288
    ds_read_b64_tr_b16 v[114:115], v6 offset:12544
    s_waitcnt lgkmcnt(10)
    v_mfma_f32_32x32x16_bf16 v[32:47], v[140:143], v[164:167], v[32:47]
    ds_read_b64_tr_b16 v[116:117], v6 offset:13312
    ds_read_b64_tr_b16 v[118:119], v6 offset:13568
    buffer_load_dwordx4 v[196:199], v5, s[28:31], s62 offen offset:1024
    s_waitcnt lgkmcnt(10)
    v_mfma_f32_32x32x16_bf16 v[48:63], v[144:147], v[164:167], v[48:63]
    ds_read_b64_tr_b16 v[120:121], v6 offset:14336
    ds_read_b64_tr_b16 v[122:123], v6 offset:14592
    s_waitcnt lgkmcnt(10)
    v_mfma_f32_32x32x16_bf16 v[64:79], v[148:151], v[164:167], v[64:79]
    ds_read_b64_tr_b16 v[124:125], v6 offset:15360
    ds_read_b64_tr_b16 v[126:127], v6 offset:15616
    s_add_u32 m0, s60, 52224
    s_add_u32 s61, s40, 393216
    buffer_load_dwordx4 v4, s[20:23], s61 offen lds
    s_waitcnt lgkmcnt(10)
    v_mfma_f32_32x32x16_bf16 v[80:95], v[152:155], v[164:167], v[80:95]
    ds_read_b64_tr_b16 v[128:129], v6 offset:16384
    ds_read_b64_tr_b16 v[130:131], v6 offset:16640
    buffer_load_dwordx4 v[200:203], v5, s[28:31], s62 offen offset:2048
    s_waitcnt lgkmcnt(10)
    v_mfma_f32_32x32x16_bf16 v[96:111], v[156:159], v[164:167], v[96:111]
    ds_read_b64_tr_b16 v[132:133], v6 offset:17408
    ds_read_b64_tr_b16 v[134:135], v6 offset:17664
    s_waitcnt lgkmcnt(10)
    v_mfma_f32_32x32x16_bf16 v[16:31], v[112:115], v[168:171], v[16:31]
    ds_read_b64_tr_b16 v[136:137], v6 offset:18432
    ds_read_b64_tr_b16 v[138:139], v6 offset:18688
    s_add_u32 m0, s60, 53248
    s_add_u32 s61, s40, 393280
    buffer_load_dwordx4 v4, s[20:23], s61 offen lds
    s_waitcnt lgkmcnt(10)
    v_mfma_f32_32x32x16_bf16 v[32:47], v[116:119], v[168:171], v[32:47]
    ds_read_b64_tr_b16 v[140:141], v6 offset:19456
    ds_read_b64_tr_b16 v[142:143], v6 offset:19712
    s_waitcnt lgkmcnt(10)
    v_mfma_f32_32x32x16_bf16 v[48:63], v[120:123], v[168:171], v[48:63]
    ds_read_b64_tr_b16 v[144:145], v6 offset:20480
    ds_read_b64_tr_b16 v[146:147], v6 offset:20736
    buffer_load_dwordx4 v[204:207], v5, s[28:31], s62 offen offset:3072
    s_waitcnt lgkmcnt(10)
    v_mfma_f32_32x32x16_bf16 v[64:79], v[124:127], v[168:171], v[64:79]
    ds_read_b64_tr_b16 v[148:149], v6 offset:21504
    ds_read_b64_tr_b16 v[150:151], v6 offset:21760
    s_waitcnt lgkmcnt(10)
    v_mfma_f32_32x32x16_bf16 v[80:95], v[128:131], v[168:171], v[80:95]
    ds_read_b64_tr_b16 v[152:153], v6 offset:22528
    ds_read_b64_tr_b16 v[154:155], v6 offset:22784
    s_add_u32 m0, s60, 54272
    s_add_u32 s61, s40, 393344
    buffer_load_dwordx4 v4, s[20:23], s61 offen lds
    s_waitcnt lgkmcnt(10)
    v_mfma_f32_32x32x16_bf16 v[96:111], v[132:135], v[168:171], v[96:111]
    ds_read_b64_tr_b16 v[156:157], v6 offset:23552
    ds_read_b64_tr_b16 v[158:159], v6 offset:23808
    s_waitcnt lgkmcnt(10)
    v_mfma_f32_32x32x16_bf16 v[16:31], v[136:139], v[172:175], v[16:31]
    s_waitcnt lgkmcnt(8)
    v_mfma_f32_32x32x16_bf16 v[32:47], v[140:143], v[172:175], v[32:47]
    s_waitcnt lgkmcnt(6)
    v_mfma_f32_32x32x16_bf16 v[48:63], v[144:147], v[172:175], v[48:63]
    s_waitcnt vmcnt(10) lgkmcnt(0)
    s_barrier
    v_mfma_f32_32x32x16_bf16 v[64:79], v[148:151], v[172:175], v[64:79]
    ds_read_b64_tr_b16 v[112:113], v6 offset:24576
    ds_read_b64_tr_b16 v[114:115], v6 offset:24832
    ds_read_b64_tr_b16 v[116:117], v6 offset:25600
    ds_read_b64_tr_b16 v[118:119], v6 offset:25856
    v_mfma_f32_32x32x16_bf16 v[80:95], v[152:155], v[172:175], v[80:95]
    ds_read_b64_tr_b16 v[120:121], v6 offset:26624
    ds_read_b64_tr_b16 v[122:123], v6 offset:26880
    ds_read_b64_tr_b16 v[124:125], v6 offset:27648
    ds_read_b64_tr_b16 v[126:127], v6 offset:27904
    v_mfma_f32_32x32x16_bf16 v[96:111], v[156:159], v[172:175], v[96:111]
    ds_read_b64_tr_b16 v[128:129], v6 offset:28672
    ds_read_b64_tr_b16 v[130:131], v6 offset:28928
    ds_read_b64_tr_b16 v[132:133], v6 offset:29696
    ds_read_b64_tr_b16 v[134:135], v6 offset:29952
    s_waitcnt lgkmcnt(10)
    v_mfma_f32_32x32x16_bf16 v[16:31], v[112:115], v[176:179], v[16:31]
    ds_read_b64_tr_b16 v[136:137], v6 offset:30720
    ds_read_b64_tr_b16 v[138:139], v6 offset:30976
    s_add_u32 m0, s60, 0
    s_add_u32 s61, s40, 589824
    buffer_load_dwordx4 v4, s[16:19], s61 offen lds
    s_waitcnt lgkmcnt(10)
    v_mfma_f32_32x32x16_bf16 v[32:47], v[116:119], v[176:179], v[32:47]
    ds_read_b64_tr_b16 v[140:141], v6 offset:31744
    ds_read_b64_tr_b16 v[142:143], v6 offset:32000
    s_add_u32 m0, s60, 1024
    s_add_u32 s61, s40, 589888
    buffer_load_dwordx4 v4, s[16:19], s61 offen lds
    s_waitcnt lgkmcnt(10)
    v_mfma_f32_32x32x16_bf16 v[48:63], v[120:123], v[176:179], v[48:63]
    ds_read_b64_tr_b16 v[144:145], v6 offset:32768
    ds_read_b64_tr_b16 v[146:147], v6 offset:33024
    s_waitcnt lgkmcnt(10)
    v_mfma_f32_32x32x16_bf16 v[64:79], v[124:127], v[176:179], v[64:79]
    ds_read_b64_tr_b16 v[148:149], v6 offset:33792
    ds_read_b64_tr_b16 v[150:151], v6 offset:34048
    s_add_u32 s62, s43, 12288
    buffer_load_dwordx4 v[160:163], v5, s[28:31], s62 offen offset:0
    s_waitcnt lgkmcnt(10)
    v_mfma_f32_32x32x16_bf16 v[80:95], v[128:131], v[176:179], v[80:95]
    ds_read_b64_tr_b16 v[152:153], v6 offset:34816
    ds_read_b64_tr_b16 v[154:155], v6 offset:35072
    s_waitcnt lgkmcnt(10)
    v_mfma_f32_32x32x16_bf16 v[96:111], v[132:135], v[176:179], v[96:111]
    ds_read_b64_tr_b16 v[156:157], v6 offset:35840
    ds_read_b64_tr_b16 v[158:159], v6 offset:36096
    s_add_u32 m0, s60, 2048
    s_add_u32 s61, s40, 589952
    buffer_load_dwordx4 v4, s[16:19], s61 offen lds
    s_waitcnt lgkmcnt(10)
    v_mfma_f32_32x32x16_bf16 v[16:31], v[136:139], v[180:183], v[16:31]
    ds_read_b64_tr_b16 v[112:113], v6 offset:36864
    ds_read_b64_tr_b16 v[114:115], v6 offset:37120
    s_waitcnt lgkmcnt(10)
    v_mfma_f32_32x32x16_bf16 v[32:47], v[140:143], v[180:183], v[32:47]
    ds_read_b64_tr_b16 v[116:117], v6 offset:37888
    ds_read_b64_tr_b16 v[118:119], v6 offset:38144
    buffer_load_dwordx4 v[164:167], v5, s[28:31], s62 offen offset:1024
    s_waitcnt lgkmcnt(10)
    v_mfma_f32_32x32x16_bf16 v[48:63], v[144:147], v[180:183], v[48:63]
    ds_read_b64_tr_b16 v[120:121], v6 offset:38912
    ds_read_b64_tr_b16 v[122:123], v6 offset:39168
    s_waitcnt lgkmcnt(10)
    v_mfma_f32_32x32x16_bf16 v[64:79], v[148:151], v[180:183], v[64:79]
    ds_read_b64_tr_b16 v[124:125], v6 offset:39936
    ds_read_b64_tr_b16 v[126:127], v6 offset:40192
    s_add_u32 m0, s60, 3072
    s_add_u32 s61, s40, 589824
    buffer_load_dwordx4 v4, s[20:23], s61 offen lds
    s_waitcnt lgkmcnt(10)
    v_mfma_f32_32x32x16_bf16 v[80:95], v[152:155], v[180:183], v[80:95]
    ds_read_b64_tr_b16 v[128:129], v6 offset:40960
    ds_read_b64_tr_b16 v[130:131], v6 offset:41216
    buffer_load_dwordx4 v[168:171], v5, s[28:31], s62 offen offset:2048
    s_waitcnt lgkmcnt(10)
    v_mfma_f32_32x32x16_bf16 v[96:111], v[156:159], v[180:183], v[96:111]
    ds_read_b64_tr_b16 v[132:133], v6 offset:41984
    ds_read_b64_tr_b16 v[134:135], v6 offset:42240
    s_waitcnt lgkmcnt(10)
    v_mfma_f32_32x32x16_bf16 v[16:31], v[112:115], v[184:187], v[16:31]
    ds_read_b64_tr_b16 v[136:137], v6 offset:43008
    ds_read_b64_tr_b16 v[138:139], v6 offset:43264
    s_add_u32 m0, s60, 4096
    s_add_u32 s61, s40, 589888
    buffer_load_dwordx4 v4, s[20:23], s61 offen lds
    s_waitcnt lgkmcnt(10)
    v_mfma_f32_32x32x16_bf16 v[32:47], v[116:119], v[184:187], v[32:47]
    ds_read_b64_tr_b16 v[140:141], v6 offset:44032
    ds_read_b64_tr_b16 v[142:143], v6 offset:44288
    s_waitcnt lgkmcnt(10)
    v_mfma_f32_32x32x16_bf16 v[48:63], v[120:123], v[184:187], v[48:63]
    ds_read_b64_tr_b16 v[144:145], v6 offset:45056
    ds_read_b64_tr_b16 v[146:147], v6 offset:45312
    buffer_load_dwordx4 v[172:175], v5, s[28:31], s62 offen offset:3072
    s_waitcnt lgkmcnt(10)
    v_mfma_f32_32x32x16_bf16 v[64:79], v[124:127], v[184:187], v[64:79]
    ds_read_b64_tr_b16 v[148:149], v6 offset:46080
    ds_read_b64_tr_b16 v[150:151], v6 offset:46336
    s_waitcnt lgkmcnt(10)
    v_mfma_f32_32x32x16_bf16 v[80:95], v[128:131], v[184:187], v[80:95]
    ds_read_b64_tr_b16 v[152:153], v6 offset:47104
    ds_read_b64_tr_b16 v[154:155], v6 offset:47360
    s_add_u32 m0, s60, 5120
    s_add_u32 s61, s40, 589952
    buffer_load_dwordx4 v4, s[20:23], s61 offen lds
    s_waitcnt lgkmcnt(10)
    v_mfma_f32_32x32x16_bf16 v[96:111], v[132:135], v[184:187], v[96:111]
    ds_read_b64_tr_b16 v[156:157], v6 offset:48128
    ds_read_b64_tr_b16 v[158:159], v6 offset:48384
    s_waitcnt lgkmcnt(10)
    v_mfma_f32_32x32x16_bf16 v[16:31], v[136:139], v[188:191], v[16:31]
    s_waitcnt lgkmcnt(8)
    v_mfma_f32_32x32x16_bf16 v[32:47], v[140:143], v[188:191], v[32:47]
    s_waitcnt lgkmcnt(6)
    v_mfma_f32_32x32x16_bf16 v[48:63], v[144:147], v[188:191], v[48:63]
    s_waitcnt vmcnt(10) lgkmcnt(0)
    s_barrier
    v_mfma_f32_32x32x16_bf16 v[64:79], v[148:151], v[188:191], v[64:79]
    ds_read_b64_tr_b16 v[112:113], v7 offset:0
    ds_read_b64_tr_b16 v[114:115], v7 offset:256
    ds_read_b64_tr_b16 v[116:117], v7 offset:1024
    ds_read_b64_tr_b16 v[118:119], v7 offset:1280
    v_mfma_f32_32x32x16_bf16 v[80:95], v[152:155], v[188:191], v[80:95]
    ds_read_b64_tr_b16 v[120:121], v7 offset:2048
    ds_read_b64_tr_b16 v[122:123], v7 offset:2304
    ds_read_b64_tr_b16 v[124:125], v7 offset:3072
    ds_read_b64_tr_b16 v[126:127], v7 offset:3328
    v_mfma_f32_32x32x16_bf16 v[96:111], v[156:159], v[188:191], v[96:111]
    ds_read_b64_tr_b16 v[128:129], v7 offset:4096
    ds_read_b64_tr_b16 v[130:131], v7 offset:4352
    ds_read_b64_tr_b16 v[132:133], v7 offset:5120
    ds_read_b64_tr_b16 v[134:135], v7 offset:5376
    s_waitcnt lgkmcnt(10)
    v_mfma_f32_32x32x16_bf16 v[16:31], v[112:115], v[192:195], v[16:31]
    ds_read_b64_tr_b16 v[136:137], v7 offset:6144
    ds_read_b64_tr_b16 v[138:139], v7 offset:6400
    s_add_u32 m0, s60, 24576
    s_add_u32 s61, s40, 786432
    buffer_load_dwordx4 v4, s[16:19], s61 offen lds
    s_waitcnt lgkmcnt(10)
    v_mfma_f32_32x32x16_bf16 v[32:47], v[116:119], v[192:195], v[32:47]
    ds_read_b64_tr_b16 v[140:141], v7 offset:7168
    ds_read_b64_tr_b16 v[142:143], v7 offset:7424
    s_add_u32 m0, s60, 25600
    s_add_u32 s61, s40, 786496
    buffer_load_dwordx4 v4, s[16:19], s61 offen lds
    s_waitcnt lgkmcnt(10)
    v_mfma_f32_32x32x16_bf16 v[48:63], v[120:123], v[192:195], v[48:63]
    ds_read_b64_tr_b16 v[144:145], v7 offset:8192
    ds_read_b64_tr_b16 v[146:147], v7 offset:8448
    s_waitcnt lgkmcnt(10)
    v_mfma_f32_32x32x16_bf16 v[64:79], v[124:127], v[192:195], v[64:79]
    ds_read_b64_tr_b16 v[148:149], v7 offset:9216
    ds_read_b64_tr_b16 v[150:151], v7 offset:9472
    s_add_u32 s62, s43, 16384
    buffer_load_dwordx4 v[176:179], v5, s[28:31], s62 offen offset:0
    s_waitcnt lgkmcnt(10)
    v_mfma_f32_32x32x16_bf16 v[80:95], v[128:131], v[192:195], v[80:95]
    ds_read_b64_tr_b16 v[152:153], v7 offset:10240
    ds_read_b64_tr_b16 v[154:155], v7 offset:10496
    s_waitcnt lgkmcnt(10)
    v_mfma_f32_32x32x16_bf16 v[96:111], v[132:135], v[192:195], v[96:111]
    ds_read_b64_tr_b16 v[156:157], v7 offset:11264
    ds_read_b64_tr_b16 v[158:159], v7 offset:11520
    s_add_u32 m0, s60, 26624
    s_add_u32 s61, s40, 786560
    buffer_load_dwordx4 v4, s[16:19], s61 offen lds
    s_waitcnt lgkmcnt(10)
    v_mfma_f32_32x32x16_bf16 v[16:31], v[136:139], v[196:199], v[16:31]
    ds_read_b64_tr_b16 v[112:113], v7 offset:12288
    ds_read_b64_tr_b16 v[114:115], v7 offset:12544
    s_waitcnt lgkmcnt(10)
    v_mfma_f32_32x32x16_bf16 v[32:47], v[140:143], v[196:199], v[32:47]
    ds_read_b64_tr_b16 v[116:117], v7 offset:13312
    ds_read_b64_tr_b16 v[118:119], v7 offset:13568
    buffer_load_dwordx4 v[180:183], v5, s[28:31], s62 offen offset:1024
    s_waitcnt lgkmcnt(10)
    v_mfma_f32_32x32x16_bf16 v[48:63], v[144:147], v[196:199], v[48:63]
    ds_read_b64_tr_b16 v[120:121], v7 offset:14336
    ds_read_b64_tr_b16 v[122:123], v7 offset:14592
    s_waitcnt lgkmcnt(10)
    v_mfma_f32_32x32x16_bf16 v[64:79], v[148:151], v[196:199], v[64:79]
    ds_read_b64_tr_b16 v[124:125], v7 offset:15360
    ds_read_b64_tr_b16 v[126:127], v7 offset:15616
    s_add_u32 m0, s60, 27648
    s_add_u32 s61, s40, 786432
    buffer_load_dwordx4 v4, s[20:23], s61 offen lds
    s_waitcnt lgkmcnt(10)
    v_mfma_f32_32x32x16_bf16 v[80:95], v[152:155], v[196:199], v[80:95]
    ds_read_b64_tr_b16 v[128:129], v7 offset:16384
    ds_read_b64_tr_b16 v[130:131], v7 offset:16640
    buffer_load_dwordx4 v[184:187], v5, s[28:31], s62 offen offset:2048
    s_waitcnt lgkmcnt(10)
    v_mfma_f32_32x32x16_bf16 v[96:111], v[156:159], v[196:199], v[96:111]
    ds_read_b64_tr_b16 v[132:133], v7 offset:17408
    ds_read_b64_tr_b16 v[134:135], v7 offset:17664
    s_waitcnt lgkmcnt(10)
    v_mfma_f32_32x32x16_bf16 v[16:31], v[112:115], v[200:203], v[16:31]
    ds_read_b64_tr_b16 v[136:137], v7 offset:18432
    ds_read_b64_tr_b16 v[138:139], v7 offset:18688
    s_add_u32 m0, s60, 28672
    s_add_u32 s61, s40, 786496
    buffer_load_dwordx4 v4, s[20:23], s61 offen lds
    s_waitcnt lgkmcnt(10)
    v_mfma_f32_32x32x16_bf16 v[32:47], v[116:119], v[200:203], v[32:47]
    ds_read_b64_tr_b16 v[140:141], v7 offset:19456
    ds_read_b64_tr_b16 v[142:143], v7 offset:19712
    s_waitcnt lgkmcnt(10)
    v_mfma_f32_32x32x16_bf16 v[48:63], v[120:123], v[200:203], v[48:63]
    ds_read_b64_tr_b16 v[144:145], v7 offset:20480
    ds_read_b64_tr_b16 v[146:147], v7 offset:20736
    buffer_load_dwordx4 v[188:191], v5, s[28:31], s62 offen offset:3072
    s_waitcnt lgkmcnt(10)
    v_mfma_f32_32x32x16_bf16 v[64:79], v[124:127], v[200:203], v[64:79]
    ds_read_b64_tr_b16 v[148:149], v7 offset:21504
    ds_read_b64_tr_b16 v[150:151], v7 offset:21760
    s_waitcnt lgkmcnt(10)
    v_mfma_f32_32x32x16_bf16 v[80:95], v[128:131], v[200:203], v[80:95]
    ds_read_b64_tr_b16 v[152:153], v7 offset:22528
    ds_read_b64_tr_b16 v[154:155], v7 offset:22784
    s_add_u32 m0, s60, 29696
    s_add_u32 s61, s40, 786560
    buffer_load_dwordx4 v4, s[20:23], s61 offen lds
    s_waitcnt lgkmcnt(10)
    v_mfma_f32_32x32x16_bf16 v[96:111], v[132:135], v[200:203], v[96:111]
    ds_read_b64_tr_b16 v[156:157], v7 offset:23552
    ds_read_b64_tr_b16 v[158:159], v7 offset:23808
    s_waitcnt lgkmcnt(10)
    v_mfma_f32_32x32x16_bf16 v[16:31], v[136:139], v[204:207], v[16:31]
    s_waitcnt lgkmcnt(8)
    v_mfma_f32_32x32x16_bf16 v[32:47], v[140:143], v[204:207], v[32:47]
    s_waitcnt lgkmcnt(6)
    v_mfma_f32_32x32x16_bf16 v[48:63], v[144:147], v[204:207], v[48:63]
    s_waitcnt vmcnt(10) lgkmcnt(0)
    s_barrier
    v_mfma_f32_32x32x16_bf16 v[64:79], v[148:151], v[204:207], v[64:79]
    ds_read_b64_tr_b16 v[112:113], v6 offset:0
    ds_read_b64_tr_b16 v[114:115], v6 offset:256
    ds_read_b64_tr_b16 v[116:117], v6 offset:1024
    ds_read_b64_tr_b16 v[118:119], v6 offset:1280
    v_mfma_f32_32x32x16_bf16 v[80:95], v[152:155], v[204:207], v[80:95]
    ds_read_b64_tr_b16 v[120:121], v6 offset:2048
    ds_read_b64_tr_b16 v[122:123], v6 offset:2304
    ds_read_b64_tr_b16 v[124:125], v6 offset:3072
    ds_read_b64_tr_b16 v[126:127], v6 offset:3328
    v_mfma_f32_32x32x16_bf16 v[96:111], v[156:159], v[204:207], v[96:111]
    ds_read_b64_tr_b16 v[128:129], v6 offset:4096
    ds_read_b64_tr_b16 v[130:131], v6 offset:4352
    ds_read_b64_tr_b16 v[132:133], v6 offset:5120
    ds_read_b64_tr_b16 v[134:135], v6 offset:5376
    s_waitcnt lgkmcnt(10)
    v_mfma_f32_32x32x16_bf16 v[16:31], v[112:115], v[160:163], v[16:31]
    ds_read_b64_tr_b16 v[136:137], v6 offset:6144
    ds_read_b64_tr_b16 v[138:139], v6 offset:6400
    s_add_u32 m0, s60, 49152
    s_add_u32 s61, s40, 983040
    buffer_load_dwordx4 v4, s[16:19], s61 offen lds
    s_waitcnt lgkmcnt(10)
    v_mfma_f32_32x32x16_bf16 v[32:47], v[116:119], v[160:163], v[32:47]
    ds_read_b64_tr_b16 v[140:141], v6 offset:7168
    ds_read_b64_tr_b16 v[142:143], v6 offset:7424
    s_add_u32 m0, s60, 50176
    s_add_u32 s61, s40, 983104
    buffer_load_dwordx4 v4, s[16:19], s61 offen lds
    s_waitcnt lgkmcnt(10)
    v_mfma_f32_32x32x16_bf16 v[48:63], v[120:123], v[160:163], v[48:63]
    ds_read_b64_tr_b16 v[144:145], v6 offset:8192
    ds_read_b64_tr_b16 v[146:147], v6 offset:8448
    s_waitcnt lgkmcnt(10)
    v_mfma_f32_32x32x16_bf16 v[64:79], v[124:127], v[160:163], v[64:79]
    ds_read_b64_tr_b16 v[148:149], v6 offset:9216
    ds_read_b64_tr_b16 v[150:151], v6 offset:9472
    s_add_u32 s62, s43, 20480
    buffer_load_dwordx4 v[192:195], v5, s[28:31], s62 offen offset:0
    s_waitcnt lgkmcnt(10)
    v_mfma_f32_32x32x16_bf16 v[80:95], v[128:131], v[160:163], v[80:95]
    ds_read_b64_tr_b16 v[152:153], v6 offset:10240
    ds_read_b64_tr_b16 v[154:155], v6 offset:10496
    s_waitcnt lgkmcnt(10)
    v_mfma_f32_32x32x16_bf16 v[96:111], v[132:135], v[160:163], v[96:111]
    ds_read_b64_tr_b16 v[156:157], v6 offset:11264
    ds_read_b64_tr_b16 v[158:159], v6 offset:11520
    s_add_u32 m0, s60, 51200
    s_add_u32 s61, s40, 983168
    buffer_load_dwordx4 v4, s[16:19], s61 offen lds
    s_waitcnt lgkmcnt(10)
    v_mfma_f32_32x32x16_bf16 v[16:31], v[136:139], v[164:167], v[16:31]
    ds_read_b64_tr_b16 v[112:113], v6 offset:12288
    ds_read_b64_tr_b16 v[114:115], v6 offset:12544
    s_waitcnt lgkmcnt(10)
    v_mfma_f32_32x32x16_bf16 v[32:47], v[140:143], v[164:167], v[32:47]
    ds_read_b64_tr_b16 v[116:117], v6 offset:13312
    ds_read_b64_tr_b16 v[118:119], v6 offset:13568
    buffer_load_dwordx4 v[196:199], v5, s[28:31], s62 offen offset:1024
    s_waitcnt lgkmcnt(10)
    v_mfma_f32_32x32x16_bf16 v[48:63], v[144:147], v[164:167], v[48:63]
    ds_read_b64_tr_b16 v[120:121], v6 offset:14336
    ds_read_b64_tr_b16 v[122:123], v6 offset:14592
    s_waitcnt lgkmcnt(10)
    v_mfma_f32_32x32x16_bf16 v[64:79], v[148:151], v[164:167], v[64:79]
    ds_read_b64_tr_b16 v[124:125], v6 offset:15360
    ds_read_b64_tr_b16 v[126:127], v6 offset:15616
    s_add_u32 m0, s60, 52224
    s_add_u32 s61, s40, 983040
    buffer_load_dwordx4 v4, s[20:23], s61 offen lds
    s_waitcnt lgkmcnt(10)
    v_mfma_f32_32x32x16_bf16 v[80:95], v[152:155], v[164:167], v[80:95]
    ds_read_b64_tr_b16 v[128:129], v6 offset:16384
    ds_read_b64_tr_b16 v[130:131], v6 offset:16640
    buffer_load_dwordx4 v[200:203], v5, s[28:31], s62 offen offset:2048
    s_waitcnt lgkmcnt(10)
    v_mfma_f32_32x32x16_bf16 v[96:111], v[156:159], v[164:167], v[96:111]
    ds_read_b64_tr_b16 v[132:133], v6 offset:17408
    ds_read_b64_tr_b16 v[134:135], v6 offset:17664
    s_waitcnt lgkmcnt(10)
    v_mfma_f32_32x32x16_bf16 v[16:31], v[112:115], v[168:171], v[16:31]
    ds_read_b64_tr_b16 v[136:137], v6 offset:18432
    ds_read_b64_tr_b16 v[138:139], v6 offset:18688
    s_add_u32 m0, s60, 53248
    s_add_u32 s61, s40, 983104
    buffer_load_dwordx4 v4, s[20:23], s61 offen lds
    s_waitcnt lgkmcnt(10)
    v_mfma_f32_32x32x16_bf16 v[32:47], v[116:119], v[168:171], v[32:47]
    ds_read_b64_tr_b16 v[140:141], v6 offset:19456
    ds_read_b64_tr_b16 v[142:143], v6 offset:19712
    s_waitcnt lgkmcnt(10)
    v_mfma_f32_32x32x16_bf16 v[48:63], v[120:123], v[168:171], v[48:63]
    ds_read_b64_tr_b16 v[144:145], v6 offset:20480
    ds_read_b64_tr_b16 v[146:147], v6 offset:20736
    buffer_load_dwordx4 v[204:207], v5, s[28:31], s62 offen offset:3072
    s_waitcnt lgkmcnt(10)
    v_mfma_f32_32x32x16_bf16 v[64:79], v[124:127], v[168:171], v[64:79]
    ds_read_b64_tr_b16 v[148:149], v6 offset:21504
    ds_read_b64_tr_b16 v[150:151], v6 offset:21760
    s_waitcnt lgkmcnt(10)
    v_mfma_f32_32x32x16_bf16 v[80:95], v[128:131], v[168:171], v[80:95]
    ds_read_b64_tr_b16 v[152:153], v6 offset:22528
    ds_read_b64_tr_b16 v[154:155], v6 offset:22784
    s_add_u32 m0, s60, 54272
    s_add_u32 s61, s40, 983168
    buffer_load_dwordx4 v4, s[20:23], s61 offen lds
    s_waitcnt lgkmcnt(10)
    v_mfma_f32_32x32x16_bf16 v[96:111], v[132:135], v[168:171], v[96:111]
    ds_read_b64_tr_b16 v[156:157], v6 offset:23552
    ds_read_b64_tr_b16 v[158:159], v6 offset:23808
    s_waitcnt lgkmcnt(10)
    v_mfma_f32_32x32x16_bf16 v[16:31], v[136:139], v[172:175], v[16:31]
    s_waitcnt lgkmcnt(8)
    v_mfma_f32_32x32x16_bf16 v[32:47], v[140:143], v[172:175], v[32:47]
    s_waitcnt lgkmcnt(6)
    v_mfma_f32_32x32x16_bf16 v[48:63], v[144:147], v[172:175], v[48:63]
    s_waitcnt vmcnt(10) lgkmcnt(0)
    s_barrier
    v_mfma_f32_32x32x16_bf16 v[64:79], v[148:151], v[172:175], v[64:79]
    ds_read_b64_tr_b16 v[112:113], v6 offset:24576
    ds_read_b64_tr_b16 v[114:115], v6 offset:24832
    ds_read_b64_tr_b16 v[116:117], v6 offset:25600
    ds_read_b64_tr_b16 v[118:119], v6 offset:25856
    v_mfma_f32_32x32x16_bf16 v[80:95], v[152:155], v[172:175], v[80:95]
    ds_read_b64_tr_b16 v[120:121], v6 offset:26624
    ds_read_b64_tr_b16 v[122:123], v6 offset:26880
    ds_read_b64_tr_b16 v[124:125], v6 offset:27648
    ds_read_b64_tr_b16 v[126:127], v6 offset:27904
    v_mfma_f32_32x32x16_bf16 v[96:111], v[156:159], v[172:175], v[96:111]
    ds_read_b64_tr_b16 v[128:129], v6 offset:28672
    ds_read_b64_tr_b16 v[130:131], v6 offset:28928
    ds_read_b64_tr_b16 v[132:133], v6 offset:29696
    ds_read_b64_tr_b16 v[134:135], v6 offset:29952
    s_waitcnt lgkmcnt(10)
    v_mfma_f32_32x32x16_bf16 v[16:31], v[112:115], v[176:179], v[16:31]
    ds_read_b64_tr_b16 v[136:137], v6 offset:30720
    ds_read_b64_tr_b16 v[138:139], v6 offset:30976
    s_add_u32 m0, s60, 0
    s_add_u32 s61, s40, 1179648
    buffer_load_dwordx4 v4, s[16:19], s61 offen lds
    s_waitcnt lgkmcnt(10)
    v_mfma_f32_32x32x16_bf16 v[32:47], v[116:119], v[176:179], v[32:47]
    ds_read_b64_tr_b16 v[140:141], v6 offset:31744
    ds_read_b64_tr_b16 v[142:143], v6 offset:32000
    s_add_u32 m0, s60, 1024
    s_add_u32 s61, s40, 1179712
    buffer_load_dwordx4 v4, s[16:19], s61 offen lds
    s_waitcnt lgkmcnt(10)
    v_mfma_f32_32x32x16_bf16 v[48:63], v[120:123], v[176:179], v[48:63]
    ds_read_b64_tr_b16 v[144:145], v6 offset:32768
    ds_read_b64_tr_b16 v[146:147], v6 offset:33024
    s_waitcnt lgkmcnt(10)
    v_mfma_f32_32x32x16_bf16 v[64:79], v[124:127], v[176:179], v[64:79]
    ds_read_b64_tr_b16 v[148:149], v6 offset:33792
    ds_read_b64_tr_b16 v[150:151], v6 offset:34048
    s_add_u32 s62, s43, 24576
    buffer_load_dwordx4 v[160:163], v5, s[28:31], s62 offen offset:0
    s_waitcnt lgkmcnt(10)
    v_mfma_f32_32x32x16_bf16 v[80:95], v[128:131], v[176:179], v[80:95]
    ds_read_b64_tr_b16 v[152:153], v6 offset:34816
    ds_read_b64_tr_b16 v[154:155], v6 offset:35072
    s_waitcnt lgkmcnt(10)
    v_mfma_f32_32x32x16_bf16 v[96:111], v[132:135], v[176:179], v[96:111]
    ds_read_b64_tr_b16 v[156:157], v6 offset:35840
    ds_read_b64_tr_b16 v[158:159], v6 offset:36096
    s_add_u32 m0, s60, 2048
    s_add_u32 s61, s40, 1179776
    buffer_load_dwordx4 v4, s[16:19], s61 offen lds
    s_waitcnt lgkmcnt(10)
    v_mfma_f32_32x32x16_bf16 v[16:31], v[136:139], v[180:183], v[16:31]
    ds_read_b64_tr_b16 v[112:113], v6 offset:36864
    ds_read_b64_tr_b16 v[114:115], v6 offset:37120
    s_waitcnt lgkmcnt(10)
    v_mfma_f32_32x32x16_bf16 v[32:47], v[140:143], v[180:183], v[32:47]
    ds_read_b64_tr_b16 v[116:117], v6 offset:37888
    ds_read_b64_tr_b16 v[118:119], v6 offset:38144
    buffer_load_dwordx4 v[164:167], v5, s[28:31], s62 offen offset:1024
    s_waitcnt lgkmcnt(10)
    v_mfma_f32_32x32x16_bf16 v[48:63], v[144:147], v[180:183], v[48:63]
    ds_read_b64_tr_b16 v[120:121], v6 offset:38912
    ds_read_b64_tr_b16 v[122:123], v6 offset:39168
    s_waitcnt lgkmcnt(10)
    v_mfma_f32_32x32x16_bf16 v[64:79], v[148:151], v[180:183], v[64:79]
    ds_read_b64_tr_b16 v[124:125], v6 offset:39936
    ds_read_b64_tr_b16 v[126:127], v6 offset:40192
    s_add_u32 m0, s60, 3072
    s_add_u32 s61, s40, 1179648
    buffer_load_dwordx4 v4, s[20:23], s61 offen lds
    s_waitcnt lgkmcnt(10)
    v_mfma_f32_32x32x16_bf16 v[80:95], v[152:155], v[180:183], v[80:95]
    ds_read_b64_tr_b16 v[128:129], v6 offset:40960
    ds_read_b64_tr_b16 v[130:131], v6 offset:41216
    buffer_load_dwordx4 v[168:171], v5, s[28:31], s62 offen offset:2048
    s_waitcnt lgkmcnt(10)
    v_mfma_f32_32x32x16_bf16 v[96:111], v[156:159], v[180:183], v[96:111]
    ds_read_b64_tr_b16 v[132:133], v6 offset:41984
    ds_read_b64_tr_b16 v[134:135], v6 offset:42240
    s_waitcnt lgkmcnt(10)
    v_mfma_f32_32x32x16_bf16 v[16:31], v[112:115], v[184:187], v[16:31]
    ds_read_b64_tr_b16 v[136:137], v6 offset:43008
    ds_read_b64_tr_b16 v[138:139], v6 offset:43264
    s_add_u32 m0, s60, 4096
    s_add_u32 s61, s40, 1179712
    buffer_load_dwordx4 v4, s[20:23], s61 offen lds
    s_waitcnt lgkmcnt(10)
    v_mfma_f32_32x32x16_bf16 v[32:47], v[116:119], v[184:187], v[32:47]
    ds_read_b64_tr_b16 v[140:141], v6 offset:44032
    ds_read_b64_tr_b16 v[142:143], v6 offset:44288
    s_waitcnt lgkmcnt(10)
    v_mfma_f32_32x32x16_bf16 v[48:63], v[120:123], v[184:187], v[48:63]
    ds_read_b64_tr_b16 v[144:145], v6 offset:45056
    ds_read_b64_tr_b16 v[146:147], v6 offset:45312
    buffer_load_dwordx4 v[172:175], v5, s[28:31], s62 offen offset:3072
    s_waitcnt lgkmcnt(10)
    v_mfma_f32_32x32x16_bf16 v[64:79], v[124:127], v[184:187], v[64:79]
    ds_read_b64_tr_b16 v[148:149], v6 offset:46080
    ds_read_b64_tr_b16 v[150:151], v6 offset:46336
    s_waitcnt lgkmcnt(10)
    v_mfma_f32_32x32x16_bf16 v[80:95], v[128:131], v[184:187], v[80:95]
    ds_read_b64_tr_b16 v[152:153], v6 offset:47104
    ds_read_b64_tr_b16 v[154:155], v6 offset:47360
    s_add_u32 m0, s60, 5120
    s_add_u32 s61, s40, 1179776
    buffer_load_dwordx4 v4, s[20:23], s61 offen lds
    s_waitcnt lgkmcnt(10)
    v_mfma_f32_32x32x16_bf16 v[96:111], v[132:135], v[184:187], v[96:111]
    ds_read_b64_tr_b16 v[156:157], v6 offset:48128
    ds_read_b64_tr_b16 v[158:159], v6 offset:48384
    s_waitcnt lgkmcnt(10)
    v_mfma_f32_32x32x16_bf16 v[16:31], v[136:139], v[188:191], v[16:31]
    s_waitcnt lgkmcnt(8)
    v_mfma_f32_32x32x16_bf16 v[32:47], v[140:143], v[188:191], v[32:47]
    s_waitcnt lgkmcnt(6)
    v_mfma_f32_32x32x16_bf16 v[48:63], v[144:147], v[188:191], v[48:63]
    s_waitcnt vmcnt(10) lgkmcnt(0)
    s_barrier
    v_mfma_f32_32x32x16_bf16 v[64:79], v[148:151], v[188:191], v[64:79]
    ds_read_b64_tr_b16 v[112:113], v7 offset:0
    ds_read_b64_tr_b16 v[114:115], v7 offset:256
    ds_read_b64_tr_b16 v[116:117], v7 offset:1024
    ds_read_b64_tr_b16 v[118:119], v7 offset:1280
    v_mfma_f32_32x32x16_bf16 v[80:95], v[152:155], v[188:191], v[80:95]
    ds_read_b64_tr_b16 v[120:121], v7 offset:2048
    ds_read_b64_tr_b16 v[122:123], v7 offset:2304
    ds_read_b64_tr_b16 v[124:125], v7 offset:3072
    ds_read_b64_tr_b16 v[126:127], v7 offset:3328
    v_mfma_f32_32x32x16_bf16 v[96:111], v[156:159], v[188:191], v[96:111]
    ds_read_b64_tr_b16 v[128:129], v7 offset:4096
    ds_read_b64_tr_b16 v[130:131], v7 offset:4352
    ds_read_b64_tr_b16 v[132:133], v7 offset:5120
    ds_read_b64_tr_b16 v[134:135], v7 offset:5376
    s_waitcnt lgkmcnt(10)
    v_mfma_f32_32x32x16_bf16 v[16:31], v[112:115], v[192:195], v[16:31]
    ds_read_b64_tr_b16 v[136:137], v7 offset:6144
    ds_read_b64_tr_b16 v[138:139], v7 offset:6400
    s_add_u32 m0, s60, 24576
    s_add_u32 s61, s40, 1376256
    buffer_load_dwordx4 v4, s[16:19], s61 offen lds
    s_waitcnt lgkmcnt(10)
    v_mfma_f32_32x32x16_bf16 v[32:47], v[116:119], v[192:195], v[32:47]
    ds_read_b64_tr_b16 v[140:141], v7 offset:7168
    ds_read_b64_tr_b16 v[142:143], v7 offset:7424
    s_add_u32 m0, s60, 25600
    s_add_u32 s61, s40, 1376320
    buffer_load_dwordx4 v4, s[16:19], s61 offen lds
    s_waitcnt lgkmcnt(10)
    v_mfma_f32_32x32x16_bf16 v[48:63], v[120:123], v[192:195], v[48:63]
    ds_read_b64_tr_b16 v[144:145], v7 offset:8192
    ds_read_b64_tr_b16 v[146:147], v7 offset:8448
    s_waitcnt lgkmcnt(10)
    v_mfma_f32_32x32x16_bf16 v[64:79], v[124:127], v[192:195], v[64:79]
    ds_read_b64_tr_b16 v[148:149], v7 offset:9216
    ds_read_b64_tr_b16 v[150:151], v7 offset:9472
    s_add_u32 s62, s43, 28672
    buffer_load_dwordx4 v[176:179], v5, s[28:31], s62 offen offset:0
    s_waitcnt lgkmcnt(10)
    v_mfma_f32_32x32x16_bf16 v[80:95], v[128:131], v[192:195], v[80:95]
    ds_read_b64_tr_b16 v[152:153], v7 offset:10240
    ds_read_b64_tr_b16 v[154:155], v7 offset:10496
    s_waitcnt lgkmcnt(10)
    v_mfma_f32_32x32x16_bf16 v[96:111], v[132:135], v[192:195], v[96:111]
    ds_read_b64_tr_b16 v[156:157], v7 offset:11264
    ds_read_b64_tr_b16 v[158:159], v7 offset:11520
    s_add_u32 m0, s60, 26624
    s_add_u32 s61, s40, 1376384
    buffer_load_dwordx4 v4, s[16:19], s61 offen lds
    s_waitcnt lgkmcnt(10)
    v_mfma_f32_32x32x16_bf16 v[16:31], v[136:139], v[196:199], v[16:31]
    ds_read_b64_tr_b16 v[112:113], v7 offset:12288
    ds_read_b64_tr_b16 v[114:115], v7 offset:12544
    s_waitcnt lgkmcnt(10)
    v_mfma_f32_32x32x16_bf16 v[32:47], v[140:143], v[196:199], v[32:47]
    ds_read_b64_tr_b16 v[116:117], v7 offset:13312
    ds_read_b64_tr_b16 v[118:119], v7 offset:13568
    buffer_load_dwordx4 v[180:183], v5, s[28:31], s62 offen offset:1024
    s_waitcnt lgkmcnt(10)
    v_mfma_f32_32x32x16_bf16 v[48:63], v[144:147], v[196:199], v[48:63]
    ds_read_b64_tr_b16 v[120:121], v7 offset:14336
    ds_read_b64_tr_b16 v[122:123], v7 offset:14592
    s_waitcnt lgkmcnt(10)
    v_mfma_f32_32x32x16_bf16 v[64:79], v[148:151], v[196:199], v[64:79]
    ds_read_b64_tr_b16 v[124:125], v7 offset:15360
    ds_read_b64_tr_b16 v[126:127], v7 offset:15616
    s_add_u32 m0, s60, 27648
    s_add_u32 s61, s40, 1376256
    buffer_load_dwordx4 v4, s[20:23], s61 offen lds
    s_waitcnt lgkmcnt(10)
    v_mfma_f32_32x32x16_bf16 v[80:95], v[152:155], v[196:199], v[80:95]
    ds_read_b64_tr_b16 v[128:129], v7 offset:16384
    ds_read_b64_tr_b16 v[130:131], v7 offset:16640
    buffer_load_dwordx4 v[184:187], v5, s[28:31], s62 offen offset:2048
    s_waitcnt lgkmcnt(10)
    v_mfma_f32_32x32x16_bf16 v[96:111], v[156:159], v[196:199], v[96:111]
    ds_read_b64_tr_b16 v[132:133], v7 offset:17408
    ds_read_b64_tr_b16 v[134:135], v7 offset:17664
    s_waitcnt lgkmcnt(10)
    v_mfma_f32_32x32x16_bf16 v[16:31], v[112:115], v[200:203], v[16:31]
    ds_read_b64_tr_b16 v[136:137], v7 offset:18432
    ds_read_b64_tr_b16 v[138:139], v7 offset:18688
    s_add_u32 m0, s60, 28672
    s_add_u32 s61, s40, 1376320
    buffer_load_dwordx4 v4, s[20:23], s61 offen lds
    s_waitcnt lgkmcnt(10)
    v_mfma_f32_32x32x16_bf16 v[32:47], v[116:119], v[200:203], v[32:47]
    ds_read_b64_tr_b16 v[140:141], v7 offset:19456
    ds_read_b64_tr_b16 v[142:143], v7 offset:19712
    s_waitcnt lgkmcnt(10)
    v_mfma_f32_32x32x16_bf16 v[48:63], v[120:123], v[200:203], v[48:63]
    ds_read_b64_tr_b16 v[144:145], v7 offset:20480
    ds_read_b64_tr_b16 v[146:147], v7 offset:20736
    buffer_load_dwordx4 v[188:191], v5, s[28:31], s62 offen offset:3072
    s_waitcnt lgkmcnt(10)
    v_mfma_f32_32x32x16_bf16 v[64:79], v[124:127], v[200:203], v[64:79]
    ds_read_b64_tr_b16 v[148:149], v7 offset:21504
    ds_read_b64_tr_b16 v[150:151], v7 offset:21760
    s_waitcnt lgkmcnt(10)
    v_mfma_f32_32x32x16_bf16 v[80:95], v[128:131], v[200:203], v[80:95]
    ds_read_b64_tr_b16 v[152:153], v7 offset:22528
    ds_read_b64_tr_b16 v[154:155], v7 offset:22784
    s_add_u32 m0, s60, 29696
    s_add_u32 s61, s40, 1376384
    buffer_load_dwordx4 v4, s[20:23], s61 offen lds
    s_waitcnt lgkmcnt(10)
    v_mfma_f32_32x32x16_bf16 v[96:111], v[132:135], v[200:203], v[96:111]
    ds_read_b64_tr_b16 v[156:157], v7 offset:23552
    ds_read_b64_tr_b16 v[158:159], v7 offset:23808
    s_waitcnt lgkmcnt(10)
    v_mfma_f32_32x32x16_bf16 v[16:31], v[136:139], v[204:207], v[16:31]
    s_waitcnt lgkmcnt(8)
    v_mfma_f32_32x32x16_bf16 v[32:47], v[140:143], v[204:207], v[32:47]
    s_waitcnt lgkmcnt(6)
    v_mfma_f32_32x32x16_bf16 v[48:63], v[144:147], v[204:207], v[48:63]
    s_waitcnt vmcnt(10) lgkmcnt(0)
    s_barrier
    v_mfma_f32_32x32x16_bf16 v[64:79], v[148:151], v[204:207], v[64:79]
    ds_read_b64_tr_b16 v[112:113], v6 offset:0
    ds_read_b64_tr_b16 v[114:115], v6 offset:256
    ds_read_b64_tr_b16 v[116:117], v6 offset:1024
    ds_read_b64_tr_b16 v[118:119], v6 offset:1280
    v_mfma_f32_32x32x16_bf16 v[80:95], v[152:155], v[204:207], v[80:95]
    ds_read_b64_tr_b16 v[120:121], v6 offset:2048
    ds_read_b64_tr_b16 v[122:123], v6 offset:2304
    ds_read_b64_tr_b16 v[124:125], v6 offset:3072
    ds_read_b64_tr_b16 v[126:127], v6 offset:3328
    v_mfma_f32_32x32x16_bf16 v[96:111], v[156:159], v[204:207], v[96:111]
    ds_read_b64_tr_b16 v[128:129], v6 offset:4096
    ds_read_b64_tr_b16 v[130:131], v6 offset:4352
    ds_read_b64_tr_b16 v[132:133], v6 offset:5120
    ds_read_b64_tr_b16 v[134:135], v6 offset:5376
    s_waitcnt lgkmcnt(10)
    v_mfma_f32_32x32x16_bf16 v[16:31], v[112:115], v[160:163], v[16:31]
    ds_read_b64_tr_b16 v[136:137], v6 offset:6144
    ds_read_b64_tr_b16 v[138:139], v6 offset:6400
    s_add_u32 m0, s60, 49152
    s_add_u32 s61, s40, 1572864
    buffer_load_dwordx4 v4, s[16:19], s61 offen lds
    s_waitcnt lgkmcnt(10)
    v_mfma_f32_32x32x16_bf16 v[32:47], v[116:119], v[160:163], v[32:47]
    ds_read_b64_tr_b16 v[140:141], v6 offset:7168
    ds_read_b64_tr_b16 v[142:143], v6 offset:7424
    s_add_u32 m0, s60, 50176
    s_add_u32 s61, s40, 1572928
    buffer_load_dwordx4 v4, s[16:19], s61 offen lds
    s_waitcnt lgkmcnt(10)
    v_mfma_f32_32x32x16_bf16 v[48:63], v[120:123], v[160:163], v[48:63]
    ds_read_b64_tr_b16 v[144:145], v6 offset:8192
    ds_read_b64_tr_b16 v[146:147], v6 offset:8448
    s_waitcnt lgkmcnt(10)
    v_mfma_f32_32x32x16_bf16 v[64:79], v[124:127], v[160:163], v[64:79]
    ds_read_b64_tr_b16 v[148:149], v6 offset:9216
    ds_read_b64_tr_b16 v[150:151], v6 offset:9472
    s_add_u32 s62, s43, 32768
    buffer_load_dwordx4 v[192:195], v5, s[28:31], s62 offen offset:0
    s_waitcnt lgkmcnt(10)
    v_mfma_f32_32x32x16_bf16 v[80:95], v[128:131], v[160:163], v[80:95]
    ds_read_b64_tr_b16 v[152:153], v6 offset:10240
    ds_read_b64_tr_b16 v[154:155], v6 offset:10496
    s_add_u32 m0, s60, 51200
    s_add_u32 s61, s40, 1572992
    buffer_load_dwordx4 v4, s[16:19], s61 offen lds
    s_waitcnt lgkmcnt(10)
    v_mfma_f32_32x32x16_bf16 v[96:111], v[132:135], v[160:163], v[96:111]
    ds_read_b64_tr_b16 v[156:157], v6 offset:11264
    ds_read_b64_tr_b16 v[158:159], v6 offset:11520
    s_waitcnt lgkmcnt(10)
    v_mfma_f32_32x32x16_bf16 v[16:31], v[136:139], v[164:167], v[16:31]
    ds_read_b64_tr_b16 v[112:113], v6 offset:12288
    ds_read_b64_tr_b16 v[114:115], v6 offset:12544
    buffer_load_dwordx4 v[196:199], v5, s[28:31], s62 offen offset:1024
    s_waitcnt lgkmcnt(10)
    v_mfma_f32_32x32x16_bf16 v[32:47], v[140:143], v[164:167], v[32:47]
    ds_read_b64_tr_b16 v[116:117], v6 offset:13312
    ds_read_b64_tr_b16 v[118:119], v6 offset:13568
    s_waitcnt lgkmcnt(10)
    v_mfma_f32_32x32x16_bf16 v[48:63], v[144:147], v[164:167], v[48:63]
    ds_read_b64_tr_b16 v[120:121], v6 offset:14336
    ds_read_b64_tr_b16 v[122:123], v6 offset:14592
    s_add_u32 m0, s60, 52224
    s_add_u32 s61, s40, 1572864
    buffer_load_dwordx4 v4, s[20:23], s61 offen lds
    s_waitcnt lgkmcnt(10)
    v_mfma_f32_32x32x16_bf16 v[64:79], v[148:151], v[164:167], v[64:79]
    ds_read_b64_tr_b16 v[124:125], v6 offset:15360
    ds_read_b64_tr_b16 v[126:127], v6 offset:15616
    buffer_load_dwordx4 v[200:203], v5, s[28:31], s62 offen offset:2048
    s_waitcnt lgkmcnt(10)
    v_mfma_f32_32x32x16_bf16 v[80:95], v[152:155], v[164:167], v[80:95]
    ds_read_b64_tr_b16 v[128:129], v6 offset:16384
    ds_read_b64_tr_b16 v[130:131], v6 offset:16640
    s_waitcnt lgkmcnt(10)
    v_mfma_f32_32x32x16_bf16 v[96:111], v[156:159], v[164:167], v[96:111]
    ds_read_b64_tr_b16 v[132:133], v6 offset:17408
    ds_read_b64_tr_b16 v[134:135], v6 offset:17664
    s_add_u32 m0, s60, 53248
    s_add_u32 s61, s40, 1572928
    buffer_load_dwordx4 v4, s[20:23], s61 offen lds
    s_waitcnt lgkmcnt(10)
    v_mfma_f32_32x32x16_bf16 v[16:31], v[112:115], v[168:171], v[16:31]
    ds_read_b64_tr_b16 v[136:137], v6 offset:18432
    ds_read_b64_tr_b16 v[138:139], v6 offset:18688
    s_waitcnt lgkmcnt(10)
    v_mfma_f32_32x32x16_bf16 v[32:47], v[116:119], v[168:171], v[32:47]
    ds_read_b64_tr_b16 v[140:141], v6 offset:19456
    ds_read_b64_tr_b16 v[142:143], v6 offset:19712
    buffer_load_dwordx4 v[204:207], v5, s[28:31], s62 offen offset:3072
    s_waitcnt lgkmcnt(10)
    v_mfma_f32_32x32x16_bf16 v[48:63], v[120:123], v[168:171], v[48:63]
    ds_read_b64_tr_b16 v[144:145], v6 offset:20480
    ds_read_b64_tr_b16 v[146:147], v6 offset:20736
    s_add_u32 m0, s60, 54272
    s_add_u32 s61, s40, 1572992
    buffer_load_dwordx4 v4, s[20:23], s61 offen lds
    s_waitcnt lgkmcnt(10)
    v_mfma_f32_32x32x16_bf16 v[64:79], v[124:127], v[168:171], v[64:79]
    ds_read_b64_tr_b16 v[148:149], v6 offset:21504
    ds_read_b64_tr_b16 v[150:151], v6 offset:21760
    s_waitcnt lgkmcnt(10)
    v_mfma_f32_32x32x16_bf16 v[80:95], v[128:131], v[168:171], v[80:95]
    ds_read_b64_tr_b16 v[152:153], v6 offset:22528
    ds_read_b64_tr_b16 v[154:155], v6 offset:22784
    s_add_u32 s97, s96, 0
    buffer_load_dword v12, v11, s[24:27], s97 offen
    s_waitcnt lgkmcnt(10)
    v_mfma_f32_32x32x16_bf16 v[96:111], v[132:135], v[168:171], v[96:111]
    ds_read_b64_tr_b16 v[156:157], v6 offset:23552
    ds_read_b64_tr_b16 v[158:159], v6 offset:23808
    s_waitcnt lgkmcnt(10)
    v_mfma_f32_32x32x16_bf16 v[16:31], v[136:139], v[172:175], v[16:31]
    s_waitcnt lgkmcnt(8)
    v_mfma_f32_32x32x16_bf16 v[32:47], v[140:143], v[172:175], v[32:47]
    s_waitcnt lgkmcnt(6)
    v_mfma_f32_32x32x16_bf16 v[48:63], v[144:147], v[172:175], v[48:63]
    s_waitcnt vmcnt(11) lgkmcnt(0)
    s_barrier
    v_mfma_f32_32x32x16_bf16 v[64:79], v[148:151], v[172:175], v[64:79]
    ds_read_b64_tr_b16 v[112:113], v6 offset:24576
    ds_read_b64_tr_b16 v[114:115], v6 offset:24832
    ds_read_b64_tr_b16 v[116:117], v6 offset:25600
    ds_read_b64_tr_b16 v[118:119], v6 offset:25856
    v_mfma_f32_32x32x16_bf16 v[80:95], v[152:155], v[172:175], v[80:95]
    ds_read_b64_tr_b16 v[120:121], v6 offset:26624
    ds_read_b64_tr_b16 v[122:123], v6 offset:26880
    ds_read_b64_tr_b16 v[124:125], v6 offset:27648
    ds_read_b64_tr_b16 v[126:127], v6 offset:27904
    v_mfma_f32_32x32x16_bf16 v[96:111], v[156:159], v[172:175], v[96:111]
    ds_read_b64_tr_b16 v[128:129], v6 offset:28672
    ds_read_b64_tr_b16 v[130:131], v6 offset:28928
    ds_read_b64_tr_b16 v[132:133], v6 offset:29696
    ds_read_b64_tr_b16 v[134:135], v6 offset:29952
    s_waitcnt lgkmcnt(10)
    v_mfma_f32_32x32x16_bf16 v[16:31], v[112:115], v[176:179], v[16:31]
    ds_read_b64_tr_b16 v[136:137], v6 offset:30720
    ds_read_b64_tr_b16 v[138:139], v6 offset:30976
    s_add_u32 m0, s60, 0
    s_add_u32 s61, s40, 1769472
    buffer_load_dwordx4 v4, s[16:19], s61 offen lds
    s_waitcnt lgkmcnt(10)
    v_mfma_f32_32x32x16_bf16 v[32:47], v[116:119], v[176:179], v[32:47]
    ds_read_b64_tr_b16 v[140:141], v6 offset:31744
    ds_read_b64_tr_b16 v[142:143], v6 offset:32000
    s_add_u32 m0, s60, 1024
    s_add_u32 s61, s40, 1769536
    buffer_load_dwordx4 v4, s[16:19], s61 offen lds
    s_waitcnt lgkmcnt(10)
    v_mfma_f32_32x32x16_bf16 v[48:63], v[120:123], v[176:179], v[48:63]
    ds_read_b64_tr_b16 v[144:145], v6 offset:32768
    ds_read_b64_tr_b16 v[146:147], v6 offset:33024
    s_waitcnt lgkmcnt(10)
    v_mfma_f32_32x32x16_bf16 v[64:79], v[124:127], v[176:179], v[64:79]
    ds_read_b64_tr_b16 v[148:149], v6 offset:33792
    ds_read_b64_tr_b16 v[150:151], v6 offset:34048
    s_add_u32 s62, s43, 36864
    buffer_load_dwordx4 v[160:163], v5, s[28:31], s62 offen offset:0
    s_waitcnt lgkmcnt(10)
    v_mfma_f32_32x32x16_bf16 v[80:95], v[128:131], v[176:179], v[80:95]
    ds_read_b64_tr_b16 v[152:153], v6 offset:34816
    ds_read_b64_tr_b16 v[154:155], v6 offset:35072
    s_add_u32 m0, s60, 2048
    s_add_u32 s61, s40, 1769600
    buffer_load_dwordx4 v4, s[16:19], s61 offen lds
    s_waitcnt lgkmcnt(10)
    v_mfma_f32_32x32x16_bf16 v[96:111], v[132:135], v[176:179], v[96:111]
    ds_read_b64_tr_b16 v[156:157], v6 offset:35840
    ds_read_b64_tr_b16 v[158:159], v6 offset:36096
    s_waitcnt lgkmcnt(10)
    v_mfma_f32_32x32x16_bf16 v[16:31], v[136:139], v[180:183], v[16:31]
    ds_read_b64_tr_b16 v[112:113], v6 offset:36864
    ds_read_b64_tr_b16 v[114:115], v6 offset:37120
    buffer_load_dwordx4 v[164:167], v5, s[28:31], s62 offen offset:1024
    s_waitcnt lgkmcnt(10)
    v_mfma_f32_32x32x16_bf16 v[32:47], v[140:143], v[180:183], v[32:47]
    ds_read_b64_tr_b16 v[116:117], v6 offset:37888
    ds_read_b64_tr_b16 v[118:119], v6 offset:38144
    s_waitcnt lgkmcnt(10)
    v_mfma_f32_32x32x16_bf16 v[48:63], v[144:147], v[180:183], v[48:63]
    ds_read_b64_tr_b16 v[120:121], v6 offset:38912
    ds_read_b64_tr_b16 v[122:123], v6 offset:39168
    s_add_u32 m0, s60, 3072
    s_add_u32 s61, s40, 1769472
    buffer_load_dwordx4 v4, s[20:23], s61 offen lds
    s_waitcnt lgkmcnt(10)
    v_mfma_f32_32x32x16_bf16 v[64:79], v[148:151], v[180:183], v[64:79]
    ds_read_b64_tr_b16 v[124:125], v6 offset:39936
    ds_read_b64_tr_b16 v[126:127], v6 offset:40192
    buffer_load_dwordx4 v[168:171], v5, s[28:31], s62 offen offset:2048
    s_waitcnt lgkmcnt(10)
    v_mfma_f32_32x32x16_bf16 v[80:95], v[152:155], v[180:183], v[80:95]
    ds_read_b64_tr_b16 v[128:129], v6 offset:40960
    ds_read_b64_tr_b16 v[130:131], v6 offset:41216
    s_waitcnt lgkmcnt(10)
    v_mfma_f32_32x32x16_bf16 v[96:111], v[156:159], v[180:183], v[96:111]
    ds_read_b64_tr_b16 v[132:133], v6 offset:41984
    ds_read_b64_tr_b16 v[134:135], v6 offset:42240
    s_add_u32 m0, s60, 4096
    s_add_u32 s61, s40, 1769536
    buffer_load_dwordx4 v4, s[20:23], s61 offen lds
    s_waitcnt lgkmcnt(10)
    v_mfma_f32_32x32x16_bf16 v[16:31], v[112:115], v[184:187], v[16:31]
    ds_read_b64_tr_b16 v[136:137], v6 offset:43008
    ds_read_b64_tr_b16 v[138:139], v6 offset:43264
    s_waitcnt lgkmcnt(10)
    v_mfma_f32_32x32x16_bf16 v[32:47], v[116:119], v[184:187], v[32:47]
    ds_read_b64_tr_b16 v[140:141], v6 offset:44032
    ds_read_b64_tr_b16 v[142:143], v6 offset:44288
    buffer_load_dwordx4 v[172:175], v5, s[28:31], s62 offen offset:3072
    s_waitcnt lgkmcnt(10)
    v_mfma_f32_32x32x16_bf16 v[48:63], v[120:123], v[184:187], v[48:63]
    ds_read_b64_tr_b16 v[144:145], v6 offset:45056
    ds_read_b64_tr_b16 v[146:147], v6 offset:45312
    s_add_u32 m0, s60, 5120
    s_add_u32 s61, s40, 1769600
    buffer_load_dwordx4 v4, s[20:23], s61 offen lds
    s_waitcnt lgkmcnt(10)
    v_mfma_f32_32x32x16_bf16 v[64:79], v[124:127], v[184:187], v[64:79]
    ds_read_b64_tr_b16 v[148:149], v6 offset:46080
    ds_read_b64_tr_b16 v[150:151], v6 offset:46336
    s_waitcnt lgkmcnt(10)
    v_mfma_f32_32x32x16_bf16 v[80:95], v[128:131], v[184:187], v[80:95]
    ds_read_b64_tr_b16 v[152:153], v6 offset:47104
    ds_read_b64_tr_b16 v[154:155], v6 offset:47360
    s_add_u32 s97, s96, 4096
    buffer_load_dword v12, v11, s[24:27], s97 offen
    s_waitcnt lgkmcnt(10)
    v_mfma_f32_32x32x16_bf16 v[96:111], v[132:135], v[184:187], v[96:111]
    ds_read_b64_tr_b16 v[156:157], v6 offset:48128
    ds_read_b64_tr_b16 v[158:159], v6 offset:48384
    s_waitcnt lgkmcnt(10)
    v_mfma_f32_32x32x16_bf16 v[16:31], v[136:139], v[188:191], v[16:31]
    s_waitcnt lgkmcnt(8)
    v_mfma_f32_32x32x16_bf16 v[32:47], v[140:143], v[188:191], v[32:47]
    s_waitcnt lgkmcnt(6)
    v_mfma_f32_32x32x16_bf16 v[48:63], v[144:147], v[188:191], v[48:63]
    s_waitcnt vmcnt(12) lgkmcnt(0)
    s_barrier
    v_mfma_f32_32x32x16_bf16 v[64:79], v[148:151], v[188:191], v[64:79]
    ds_read_b64_tr_b16 v[112:113], v7 offset:0
    ds_read_b64_tr_b16 v[114:115], v7 offset:256
    ds_read_b64_tr_b16 v[116:117], v7 offset:1024
    ds_read_b64_tr_b16 v[118:119], v7 offset:1280
    v_mfma_f32_32x32x16_bf16 v[80:95], v[152:155], v[188:191], v[80:95]
    ds_read_b64_tr_b16 v[120:121], v7 offset:2048
    ds_read_b64_tr_b16 v[122:123], v7 offset:2304
    ds_read_b64_tr_b16 v[124:125], v7 offset:3072
    ds_read_b64_tr_b16 v[126:127], v7 offset:3328
    v_mfma_f32_32x32x16_bf16 v[96:111], v[156:159], v[188:191], v[96:111]
    ds_read_b64_tr_b16 v[128:129], v7 offset:4096
    ds_read_b64_tr_b16 v[130:131], v7 offset:4352
    ds_read_b64_tr_b16 v[132:133], v7 offset:5120
    ds_read_b64_tr_b16 v[134:135], v7 offset:5376
    s_waitcnt lgkmcnt(10)
    v_mfma_f32_32x32x16_bf16 v[16:31], v[112:115], v[192:195], v[16:31]
    ds_read_b64_tr_b16 v[136:137], v7 offset:6144
    ds_read_b64_tr_b16 v[138:139], v7 offset:6400
    s_add_u32 s97, s96, 8192
    buffer_load_dword v12, v11, s[24:27], s97 offen
    s_waitcnt lgkmcnt(10)
    v_mfma_f32_32x32x16_bf16 v[32:47], v[116:119], v[192:195], v[32:47]
    ds_read_b64_tr_b16 v[140:141], v7 offset:7168
    ds_read_b64_tr_b16 v[142:143], v7 offset:7424
    s_waitcnt lgkmcnt(10)
    v_mfma_f32_32x32x16_bf16 v[48:63], v[120:123], v[192:195], v[48:63]
    ds_read_b64_tr_b16 v[144:145], v7 offset:8192
    ds_read_b64_tr_b16 v[146:147], v7 offset:8448
    s_waitcnt lgkmcnt(10)
    v_mfma_f32_32x32x16_bf16 v[64:79], v[124:127], v[192:195], v[64:79]
    ds_read_b64_tr_b16 v[148:149], v7 offset:9216
    ds_read_b64_tr_b16 v[150:151], v7 offset:9472
    s_waitcnt lgkmcnt(10)
    v_mfma_f32_32x32x16_bf16 v[80:95], v[128:131], v[192:195], v[80:95]
    ds_read_b64_tr_b16 v[152:153], v7 offset:10240
    ds_read_b64_tr_b16 v[154:155], v7 offset:10496
    s_waitcnt lgkmcnt(10)
    v_mfma_f32_32x32x16_bf16 v[96:111], v[132:135], v[192:195], v[96:111]
    ds_read_b64_tr_b16 v[156:157], v7 offset:11264
    ds_read_b64_tr_b16 v[158:159], v7 offset:11520
    s_waitcnt lgkmcnt(10)
    v_mfma_f32_32x32x16_bf16 v[16:31], v[136:139], v[196:199], v[16:31]
    ds_read_b64_tr_b16 v[112:113], v7 offset:12288
    ds_read_b64_tr_b16 v[114:115], v7 offset:12544
    s_waitcnt lgkmcnt(10)
    v_mfma_f32_32x32x16_bf16 v[32:47], v[140:143], v[196:199], v[32:47]
    ds_read_b64_tr_b16 v[116:117], v7 offset:13312
    ds_read_b64_tr_b16 v[118:119], v7 offset:13568
    s_waitcnt lgkmcnt(10)
    v_mfma_f32_32x32x16_bf16 v[48:63], v[144:147], v[196:199], v[48:63]
    ds_read_b64_tr_b16 v[120:121], v7 offset:14336
    ds_read_b64_tr_b16 v[122:123], v7 offset:14592
    s_waitcnt lgkmcnt(10)
    v_mfma_f32_32x32x16_bf16 v[64:79], v[148:151], v[196:199], v[64:79]
    ds_read_b64_tr_b16 v[124:125], v7 offset:15360
    ds_read_b64_tr_b16 v[126:127], v7 offset:15616
    s_waitcnt lgkmcnt(10)
    v_mfma_f32_32x32x16_bf16 v[80:95], v[152:155], v[196:199], v[80:95]
    ds_read_b64_tr_b16 v[128:129], v7 offset:16384
    ds_read_b64_tr_b16 v[130:131], v7 offset:16640
    s_waitcnt lgkmcnt(10)
    v_mfma_f32_32x32x16_bf16 v[96:111], v[156:159], v[196:199], v[96:111]
    ds_read_b64_tr_b16 v[132:133], v7 offset:17408
    ds_read_b64_tr_b16 v[134:135], v7 offset:17664
    s_waitcnt lgkmcnt(10)
    v_mfma_f32_32x32x16_bf16 v[16:31], v[112:115], v[200:203], v[16:31]
    ds_read_b64_tr_b16 v[136:137], v7 offset:18432
    ds_read_b64_tr_b16 v[138:139], v7 offset:18688
    s_waitcnt lgkmcnt(10)
    v_mfma_f32_32x32x16_bf16 v[32:47], v[116:119], v[200:203], v[32:47]
    ds_read_b64_tr_b16 v[140:141], v7 offset:19456
    ds_read_b64_tr_b16 v[142:143], v7 offset:19712
    s_waitcnt lgkmcnt(10)
    v_mfma_f32_32x32x16_bf16 v[48:63], v[120:123], v[200:203], v[48:63]
    ds_read_b64_tr_b16 v[144:145], v7 offset:20480
    ds_read_b64_tr_b16 v[146:147], v7 offset:20736
    s_waitcnt lgkmcnt(10)
    v_mfma_f32_32x32x16_bf16 v[64:79], v[124:127], v[200:203], v[64:79]
    ds_read_b64_tr_b16 v[148:149], v7 offset:21504
    ds_read_b64_tr_b16 v[150:151], v7 offset:21760
    s_waitcnt lgkmcnt(10)
    v_mfma_f32_32x32x16_bf16 v[80:95], v[128:131], v[200:203], v[80:95]
    ds_read_b64_tr_b16 v[152:153], v7 offset:22528
    ds_read_b64_tr_b16 v[154:155], v7 offset:22784
    s_waitcnt lgkmcnt(10)
    v_mfma_f32_32x32x16_bf16 v[96:111], v[132:135], v[200:203], v[96:111]
    ds_read_b64_tr_b16 v[156:157], v7 offset:23552
    ds_read_b64_tr_b16 v[158:159], v7 offset:23808
    s_waitcnt lgkmcnt(10)
    v_mfma_f32_32x32x16_bf16 v[16:31], v[136:139], v[204:207], v[16:31]
    s_waitcnt lgkmcnt(8)
    v_mfma_f32_32x32x16_bf16 v[32:47], v[140:143], v[204:207], v[32:47]
    s_waitcnt lgkmcnt(6)
    v_mfma_f32_32x32x16_bf16 v[48:63], v[144:147], v[204:207], v[48:63]
    s_waitcnt vmcnt(2) lgkmcnt(0)
    s_barrier
    v_mfma_f32_32x32x16_bf16 v[64:79], v[148:151], v[204:207], v[64:79]
    ds_read_b64_tr_b16 v[112:113], v6 offset:0
    ds_read_b64_tr_b16 v[114:115], v6 offset:256
    ds_read_b64_tr_b16 v[116:117], v6 offset:1024
    ds_read_b64_tr_b16 v[118:119], v6 offset:1280
    v_mfma_f32_32x32x16_bf16 v[80:95], v[152:155], v[204:207], v[80:95]
    ds_read_b64_tr_b16 v[120:121], v6 offset:2048
    ds_read_b64_tr_b16 v[122:123], v6 offset:2304
    ds_read_b64_tr_b16 v[124:125], v6 offset:3072
    ds_read_b64_tr_b16 v[126:127], v6 offset:3328
    v_mfma_f32_32x32x16_bf16 v[96:111], v[156:159], v[204:207], v[96:111]
    ds_read_b64_tr_b16 v[128:129], v6 offset:4096
    ds_read_b64_tr_b16 v[130:131], v6 offset:4352
    ds_read_b64_tr_b16 v[132:133], v6 offset:5120
    ds_read_b64_tr_b16 v[134:135], v6 offset:5376
    s_waitcnt lgkmcnt(10)
    v_mfma_f32_32x32x16_bf16 v[16:31], v[112:115], v[160:163], v[16:31]
    ds_read_b64_tr_b16 v[136:137], v6 offset:6144
    ds_read_b64_tr_b16 v[138:139], v6 offset:6400
    s_add_u32 s97, s96, 12288
    buffer_load_dword v12, v11, s[24:27], s97 offen
    s_waitcnt lgkmcnt(10)
    v_mfma_f32_32x32x16_bf16 v[32:47], v[116:119], v[160:163], v[32:47]
    ds_read_b64_tr_b16 v[140:141], v6 offset:7168
    ds_read_b64_tr_b16 v[142:143], v6 offset:7424
    s_waitcnt lgkmcnt(10)
    v_mfma_f32_32x32x16_bf16 v[48:63], v[120:123], v[160:163], v[48:63]
    ds_read_b64_tr_b16 v[144:145], v6 offset:8192
    ds_read_b64_tr_b16 v[146:147], v6 offset:8448
    s_waitcnt lgkmcnt(10)
    v_mfma_f32_32x32x16_bf16 v[64:79], v[124:127], v[160:163], v[64:79]
    ds_read_b64_tr_b16 v[148:149], v6 offset:9216
    ds_read_b64_tr_b16 v[150:151], v6 offset:9472
    s_waitcnt lgkmcnt(10)
    v_mfma_f32_32x32x16_bf16 v[80:95], v[128:131], v[160:163], v[80:95]
    ds_read_b64_tr_b16 v[152:153], v6 offset:10240
    ds_read_b64_tr_b16 v[154:155], v6 offset:10496
    s_waitcnt lgkmcnt(10)
    v_mfma_f32_32x32x16_bf16 v[96:111], v[132:135], v[160:163], v[96:111]
    ds_read_b64_tr_b16 v[156:157], v6 offset:11264
    ds_read_b64_tr_b16 v[158:159], v6 offset:11520
    s_waitcnt lgkmcnt(10)
    v_mfma_f32_32x32x16_bf16 v[16:31], v[136:139], v[164:167], v[16:31]
    ds_read_b64_tr_b16 v[112:113], v6 offset:12288
    ds_read_b64_tr_b16 v[114:115], v6 offset:12544
    s_waitcnt lgkmcnt(10)
    v_mfma_f32_32x32x16_bf16 v[32:47], v[140:143], v[164:167], v[32:47]
    ds_read_b64_tr_b16 v[116:117], v6 offset:13312
    ds_read_b64_tr_b16 v[118:119], v6 offset:13568
    s_waitcnt lgkmcnt(10)
    v_mfma_f32_32x32x16_bf16 v[48:63], v[144:147], v[164:167], v[48:63]
    ds_read_b64_tr_b16 v[120:121], v6 offset:14336
    ds_read_b64_tr_b16 v[122:123], v6 offset:14592
    s_waitcnt lgkmcnt(10)
    v_mfma_f32_32x32x16_bf16 v[64:79], v[148:151], v[164:167], v[64:79]
    ds_read_b64_tr_b16 v[124:125], v6 offset:15360
    ds_read_b64_tr_b16 v[126:127], v6 offset:15616
    s_waitcnt lgkmcnt(10)
    v_mfma_f32_32x32x16_bf16 v[80:95], v[152:155], v[164:167], v[80:95]
    ds_read_b64_tr_b16 v[128:129], v6 offset:16384
    ds_read_b64_tr_b16 v[130:131], v6 offset:16640
    s_waitcnt lgkmcnt(10)
    v_mfma_f32_32x32x16_bf16 v[96:111], v[156:159], v[164:167], v[96:111]
    ds_read_b64_tr_b16 v[132:133], v6 offset:17408
    ds_read_b64_tr_b16 v[134:135], v6 offset:17664
    s_waitcnt lgkmcnt(10)
    v_mfma_f32_32x32x16_bf16 v[16:31], v[112:115], v[168:171], v[16:31]
    ds_read_b64_tr_b16 v[136:137], v6 offset:18432
    ds_read_b64_tr_b16 v[138:139], v6 offset:18688
    s_waitcnt lgkmcnt(10)
    v_mfma_f32_32x32x16_bf16 v[32:47], v[116:119], v[168:171], v[32:47]
    ds_read_b64_tr_b16 v[140:141], v6 offset:19456
    ds_read_b64_tr_b16 v[142:143], v6 offset:19712
    s_waitcnt lgkmcnt(10)
    v_mfma_f32_32x32x16_bf16 v[48:63], v[120:123], v[168:171], v[48:63]
    ds_read_b64_tr_b16 v[144:145], v6 offset:20480
    ds_read_b64_tr_b16 v[146:147], v6 offset:20736
    s_waitcnt lgkmcnt(10)
    v_mfma_f32_32x32x16_bf16 v[64:79], v[124:127], v[168:171], v[64:79]
    ds_read_b64_tr_b16 v[148:149], v6 offset:21504
    ds_read_b64_tr_b16 v[150:151], v6 offset:21760
    s_waitcnt lgkmcnt(10)
    v_mfma_f32_32x32x16_bf16 v[80:95], v[128:131], v[168:171], v[80:95]
    ds_read_b64_tr_b16 v[152:153], v6 offset:22528
    ds_read_b64_tr_b16 v[154:155], v6 offset:22784
    s_waitcnt lgkmcnt(10)
    v_mfma_f32_32x32x16_bf16 v[96:111], v[132:135], v[168:171], v[96:111]
    ds_read_b64_tr_b16 v[156:157], v6 offset:23552
    ds_read_b64_tr_b16 v[158:159], v6 offset:23808
    s_waitcnt lgkmcnt(10)
    v_mfma_f32_32x32x16_bf16 v[16:31], v[136:139], v[172:175], v[16:31]
    s_waitcnt lgkmcnt(8)
    v_mfma_f32_32x32x16_bf16 v[32:47], v[140:143], v[172:175], v[32:47]
    s_waitcnt lgkmcnt(6)
    v_mfma_f32_32x32x16_bf16 v[48:63], v[144:147], v[172:175], v[48:63]
    s_waitcnt lgkmcnt(4)
    v_mfma_f32_32x32x16_bf16 v[64:79], v[148:151], v[172:175], v[64:79]
    s_waitcnt lgkmcnt(2)
    v_mfma_f32_32x32x16_bf16 v[80:95], v[152:155], v[172:175], v[80:95]
    s_waitcnt lgkmcnt(0)
    v_mfma_f32_32x32x16_bf16 v[96:111], v[156:159], v[172:175], v[96:111]
    s_setprio 2
    s_mov_b32 s44, 0xbfb8aa3b
    s_mul_i32 s45, s42, 98304
    s_mul_i32 s46, s34, 6144
    s_add_u32 s45, s45, s46
    s_add_u32 s45, s45, 8388608
    v_mov_b32 v208, s44
    v_mov_b32 v209, s44
    v_mov_b32 v210, 1.0
    v_mov_b32 v211, 1.0
    v_pk_mul_f32 v[112:113], v[16:17], v[208:209]
    v_pk_mul_f32 v[114:115], v[18:19], v[208:209]
    v_pk_mul_f32 v[116:117], v[20:21], v[208:209]
    v_pk_mul_f32 v[118:119], v[22:23], v[208:209]
    v_pk_mul_f32 v[120:121], v[24:25], v[208:209]
    v_pk_mul_f32 v[122:123], v[26:27], v[208:209]
    v_pk_mul_f32 v[124:125], v[28:29], v[208:209]
    v_pk_mul_f32 v[126:127], v[30:31], v[208:209]
    v_exp_f32 v112, v112
    v_exp_f32 v113, v113
    v_exp_f32 v114, v114
    v_exp_f32 v115, v115
    v_exp_f32 v116, v116
    v_exp_f32 v117, v117
    v_exp_f32 v118, v118
    v_exp_f32 v119, v119
    v_exp_f32 v120, v120
    v_exp_f32 v121, v121
    v_exp_f32 v122, v122
    v_exp_f32 v123, v123
    v_exp_f32 v124, v124
    v_exp_f32 v125, v125
    v_exp_f32 v126, v126
    v_exp_f32 v127, v127
    v_pk_add_f32 v[112:113], v[112:113], v[210:211]
    v_pk_add_f32 v[114:115], v[114:115], v[210:211]
    v_pk_add_f32 v[116:117], v[116:117], v[210:211]
    v_pk_add_f32 v[118:119], v[118:119], v[210:211]
    v_pk_add_f32 v[120:121], v[120:121], v[210:211]
    v_pk_add_f32 v[122:123], v[122:123], v[210:211]
    v_pk_add_f32 v[124:125], v[124:125], v[210:211]
    v_pk_add_f32 v[126:127], v[126:127], v[210:211]
    v_rcp_f32 v112, v112
    v_rcp_f32 v113, v113
    v_rcp_f32 v114, v114
    v_rcp_f32 v115, v115
    v_rcp_f32 v116, v116
    v_rcp_f32 v117, v117
    v_rcp_f32 v118, v118
    v_rcp_f32 v119, v119
    v_rcp_f32 v120, v120
    v_rcp_f32 v121, v121
    v_rcp_f32 v122, v122
    v_rcp_f32 v123, v123
    v_rcp_f32 v124, v124
    v_rcp_f32 v125, v125
    v_rcp_f32 v126, v126
    v_rcp_f32 v127, v127
    v_pk_mul_f32 v[16:17], v[16:17], v[64:65]
    v_pk_mul_f32 v[18:19], v[18:19], v[66:67]
    v_pk_mul_f32 v[20:21], v[20:21], v[68:69]
    v_pk_mul_f32 v[22:23], v[22:23], v[70:71]
    v_pk_mul_f32 v[24:25], v[24:25], v[72:73]
    v_pk_mul_f32 v[26:27], v[26:27], v[74:75]
    v_pk_mul_f32 v[28:29], v[28:29], v[76:77]
    v_pk_mul_f32 v[30:31], v[30:31], v[78:79]
    v_pk_mul_f32 v[16:17], v[16:17], v[112:113]
    v_pk_mul_f32 v[18:19], v[18:19], v[114:115]
    v_pk_mul_f32 v[20:21], v[20:21], v[116:117]
    v_pk_mul_f32 v[22:23], v[22:23], v[118:119]
    v_pk_mul_f32 v[24:25], v[24:25], v[120:121]
    v_pk_mul_f32 v[26:27], v[26:27], v[122:123]
    v_pk_mul_f32 v[28:29], v[28:29], v[124:125]
    v_pk_mul_f32 v[30:31], v[30:31], v[126:127]
    v_cvt_pk_bf16_f32 v64, v16, v17
    v_cvt_pk_bf16_f32 v65, v18, v19
    v_cvt_pk_bf16_f32 v66, v20, v21
    v_cvt_pk_bf16_f32 v67, v22, v23
    v_cvt_pk_bf16_f32 v68, v24, v25
    v_cvt_pk_bf16_f32 v69, v26, v27
    v_cvt_pk_bf16_f32 v70, v28, v29
    v_cvt_pk_bf16_f32 v71, v30, v31
    buffer_store_dwordx4 v[64:67], v5, s[28:31], s45 offen offset:0 sc1
    buffer_store_dwordx4 v[68:71], v5, s[28:31], s45 offen offset:1024 sc1
    v_pk_mul_f32 v[112:113], v[32:33], v[208:209]
    v_pk_mul_f32 v[114:115], v[34:35], v[208:209]
    v_pk_mul_f32 v[116:117], v[36:37], v[208:209]
    v_pk_mul_f32 v[118:119], v[38:39], v[208:209]
    v_pk_mul_f32 v[120:121], v[40:41], v[208:209]
    v_pk_mul_f32 v[122:123], v[42:43], v[208:209]
    v_pk_mul_f32 v[124:125], v[44:45], v[208:209]
    v_pk_mul_f32 v[126:127], v[46:47], v[208:209]
    v_exp_f32 v112, v112
    v_exp_f32 v113, v113
    v_exp_f32 v114, v114
    v_exp_f32 v115, v115
    v_exp_f32 v116, v116
    v_exp_f32 v117, v117
    v_exp_f32 v118, v118
    v_exp_f32 v119, v119
    v_exp_f32 v120, v120
    v_exp_f32 v121, v121
    v_exp_f32 v122, v122
    v_exp_f32 v123, v123
    v_exp_f32 v124, v124
    v_exp_f32 v125, v125
    v_exp_f32 v126, v126
    v_exp_f32 v127, v127
    v_pk_add_f32 v[112:113], v[112:113], v[210:211]
    v_pk_add_f32 v[114:115], v[114:115], v[210:211]
    v_pk_add_f32 v[116:117], v[116:117], v[210:211]
    v_pk_add_f32 v[118:119], v[118:119], v[210:211]
    v_pk_add_f32 v[120:121], v[120:121], v[210:211]
    v_pk_add_f32 v[122:123], v[122:123], v[210:211]
    v_pk_add_f32 v[124:125], v[124:125], v[210:211]
    v_pk_add_f32 v[126:127], v[126:127], v[210:211]
    v_rcp_f32 v112, v112
    v_rcp_f32 v113, v113
    v_rcp_f32 v114, v114
    v_rcp_f32 v115, v115
    v_rcp_f32 v116, v116
    v_rcp_f32 v117, v117
    v_rcp_f32 v118, v118
    v_rcp_f32 v119, v119
    v_rcp_f32 v120, v120
    v_rcp_f32 v121, v121
    v_rcp_f32 v122, v122
    v_rcp_f32 v123, v123
    v_rcp_f32 v124, v124
    v_rcp_f32 v125, v125
    v_rcp_f32 v126, v126
    v_rcp_f32 v127, v127
    v_pk_mul_f32 v[32:33], v[32:33], v[80:81]
    v_pk_mul_f32 v[34:35], v[34:35], v[82:83]
    v_pk_mul_f32 v[36:37], v[36:37], v[84:85]
    v_pk_mul_f32 v[38:39], v[38:39], v[86:87]
    v_pk_mul_f32 v[40:41], v[40:41], v[88:89]
    v_pk_mul_f32 v[42:43], v[42:43], v[90:91]
    v_pk_mul_f32 v[44:45], v[44:45], v[92:93]
    v_pk_mul_f32 v[46:47], v[46:47], v[94:95]
    v_pk_mul_f32 v[32:33], v[32:33], v[112:113]
    v_pk_mul_f32 v[34:35], v[34:35], v[114:115]
    v_pk_mul_f32 v[36:37], v[36:37], v[116:117]
    v_pk_mul_f32 v[38:39], v[38:39], v[118:119]
    v_pk_mul_f32 v[40:41], v[40:41], v[120:121]
    v_pk_mul_f32 v[42:43], v[42:43], v[122:123]
    v_pk_mul_f32 v[44:45], v[44:45], v[124:125]
    v_pk_mul_f32 v[46:47], v[46:47], v[126:127]
    v_cvt_pk_bf16_f32 v80, v32, v33
    v_cvt_pk_bf16_f32 v81, v34, v35
    v_cvt_pk_bf16_f32 v82, v36, v37
    v_cvt_pk_bf16_f32 v83, v38, v39
    v_cvt_pk_bf16_f32 v84, v40, v41
    v_cvt_pk_bf16_f32 v85, v42, v43
    v_cvt_pk_bf16_f32 v86, v44, v45
    v_cvt_pk_bf16_f32 v87, v46, v47
    buffer_store_dwordx4 v[80:83], v5, s[28:31], s45 offen offset:2048 sc1
    buffer_store_dwordx4 v[84:87], v5, s[28:31], s45 offen offset:3072 sc1
    v_pk_mul_f32 v[112:113], v[48:49], v[208:209]
    v_pk_mul_f32 v[114:115], v[50:51], v[208:209]
    v_pk_mul_f32 v[116:117], v[52:53], v[208:209]
    v_pk_mul_f32 v[118:119], v[54:55], v[208:209]
    v_pk_mul_f32 v[120:121], v[56:57], v[208:209]
    v_pk_mul_f32 v[122:123], v[58:59], v[208:209]
    v_pk_mul_f32 v[124:125], v[60:61], v[208:209]
    v_pk_mul_f32 v[126:127], v[62:63], v[208:209]
    v_exp_f32 v112, v112
    v_exp_f32 v113, v113
    v_exp_f32 v114, v114
    v_exp_f32 v115, v115
    v_exp_f32 v116, v116
    v_exp_f32 v117, v117
    v_exp_f32 v118, v118
    v_exp_f32 v119, v119
    v_exp_f32 v120, v120
    v_exp_f32 v121, v121
    v_exp_f32 v122, v122
    v_exp_f32 v123, v123
    v_exp_f32 v124, v124
    v_exp_f32 v125, v125
    v_exp_f32 v126, v126
    v_exp_f32 v127, v127
    v_pk_add_f32 v[112:113], v[112:113], v[210:211]
    v_pk_add_f32 v[114:115], v[114:115], v[210:211]
    v_pk_add_f32 v[116:117], v[116:117], v[210:211]
    v_pk_add_f32 v[118:119], v[118:119], v[210:211]
    v_pk_add_f32 v[120:121], v[120:121], v[210:211]
    v_pk_add_f32 v[122:123], v[122:123], v[210:211]
    v_pk_add_f32 v[124:125], v[124:125], v[210:211]
    v_pk_add_f32 v[126:127], v[126:127], v[210:211]
    v_rcp_f32 v112, v112
    v_rcp_f32 v113, v113
    v_rcp_f32 v114, v114
    v_rcp_f32 v115, v115
    v_rcp_f32 v116, v116
    v_rcp_f32 v117, v117
    v_rcp_f32 v118, v118
    v_rcp_f32 v119, v119
    v_rcp_f32 v120, v120
    v_rcp_f32 v121, v121
    v_rcp_f32 v122, v122
    v_rcp_f32 v123, v123
    v_rcp_f32 v124, v124
    v_rcp_f32 v125, v125
    v_rcp_f32 v126, v126
    v_rcp_f32 v127, v127
    v_pk_mul_f32 v[48:49], v[48:49], v[96:97]
    v_pk_mul_f32 v[50:51], v[50:51], v[98:99]
    v_pk_mul_f32 v[52:53], v[52:53], v[100:101]
    v_pk_mul_f32 v[54:55], v[54:55], v[102:103]
    v_pk_mul_f32 v[56:57], v[56:57], v[104:105]
    v_pk_mul_f32 v[58:59], v[58:59], v[106:107]
    v_pk_mul_f32 v[60:61], v[60:61], v[108:109]
    v_pk_mul_f32 v[62:63], v[62:63], v[110:111]
    v_pk_mul_f32 v[48:49], v[48:49], v[112:113]
    v_pk_mul_f32 v[50:51], v[50:51], v[114:115]
    v_pk_mul_f32 v[52:53], v[52:53], v[116:117]
    v_pk_mul_f32 v[54:55], v[54:55], v[118:119]
    v_pk_mul_f32 v[56:57], v[56:57], v[120:121]
    v_pk_mul_f32 v[58:59], v[58:59], v[122:123]
    v_pk_mul_f32 v[60:61], v[60:61], v[124:125]
    v_pk_mul_f32 v[62:63], v[62:63], v[126:127]
    v_cvt_pk_bf16_f32 v96, v48, v49
    v_cvt_pk_bf16_f32 v97, v50, v51
    v_cvt_pk_bf16_f32 v98, v52, v53
    v_cvt_pk_bf16_f32 v99, v54, v55
    v_cvt_pk_bf16_f32 v100, v56, v57
    v_cvt_pk_bf16_f32 v101, v58, v59
    v_cvt_pk_bf16_f32 v102, v60, v61
    v_cvt_pk_bf16_f32 v103, v62, v63
    s_add_u32 s46, s45, 4096
    buffer_store_dwordx4 v[96:99], v5, s[28:31], s46 offen sc1
    s_add_u32 s46, s45, 5120
    buffer_store_dwordx4 v[100:103], v5, s[28:31], s46 offen sc1
    s_setprio 0
    s_lshl_b32 s92, s33, 8
    s_add_u32 s92, s92, 5423104
    s_lshr_b32 s93, s63, 1
    s_lshl_b32 s93, s93, 8
    s_add_u32 s93, s93, 5423104
    s_waitcnt vmcnt(0)
    s_barrier
    v_mov_b32 v224, 0
    v_mov_b32 v225, 1
    s_cmp_lg_u32 s32, 0
    s_cbranch_scc1 main_nosig
    s_mov_b64 exec, 1
    buffer_atomic_add v225, v224, s[28:31], s92 offen sc1
    s_mov_b64 exec, -1
main_nosig:
    s_cmp_ge_u32 s69, 224
    s_cbranch_scc1 main_end
    buffer_load_dwordx2 v[212:213], v10, s[76:79], s70 offen offset:0
    buffer_load_dwordx2 v[216:217], v10, s[76:79], s70 offen offset:64
    buffer_load_dwordx2 v[220:221], v10, s[76:79], s70 offen offset:128
    buffer_load_dwordx2 v[214:215], v10, s[76:79], s70 offen offset:16
    buffer_load_dwordx2 v[218:219], v10, s[76:79], s70 offen offset:80
    buffer_load_dwordx2 v[222:223], v10, s[76:79], s70 offen offset:144
    s_add_u32 m0, s67, 0
    s_add_u32 s91, s66, 0
    buffer_load_dwordx4 v8, s[24:27], s91 offen lds
    s_add_u32 m0, s67, 1024
    s_add_u32 s91, s66, 64
    buffer_load_dwordx4 v8, s[24:27], s91 offen lds
    s_add_u32 m0, s67, 2048
    s_add_u32 s91, s66, 128
    buffer_load_dwordx4 v8, s[24:27], s91 offen lds
    s_add_u32 m0, s67, 3072
    s_add_u32 s91, s66, 20480
    buffer_load_dwordx4 v8, s[24:27], s91 offen lds
    s_add_u32 m0, s67, 4096
    s_add_u32 s91, s66, 20544
    buffer_load_dwordx4 v8, s[24:27], s91 offen lds
    s_add_u32 m0, s67, 5120
    s_add_u32 s91, s66, 20608
    buffer_load_dwordx4 v8, s[24:27], s91 offen lds
    s_add_u32 m0, s67, 6144
    s_add_u32 s91, s66, 40960
    buffer_load_dwordx4 v8, s[24:27], s91 offen lds
    s_add_u32 m0, s67, 7168
    s_add_u32 s91, s66, 41024
    buffer_load_dwordx4 v8, s[24:27], s91 offen lds
    s_add_u32 m0, s67, 8192
    s_add_u32 s91, s66, 41088
    buffer_load_dwordx4 v8, s[24:27], s91 offen lds
    s_add_u32 m0, s67, 9216
    s_add_u32 s91, s66, 61440
    buffer_load_dwordx4 v8, s[24:27], s91 offen lds
    s_add_u32 m0, s67, 10240
    s_add_u32 s91, s66, 61504
    buffer_load_dwordx4 v8, s[24:27], s91 offen lds
    s_add_u32 m0, s67, 11264
    s_add_u32 s91, s66, 61568
    buffer_load_dwordx4 v8, s[24:27], s91 offen lds
    s_add_u32 m0, s67, 12288
    s_add_u32 s91, s66, 81920
    buffer_load_dwordx4 v8, s[24:27], s91 offen lds
    s_add_u32 m0, s67, 13312
    s_add_u32 s91, s66, 81984
    buffer_load_dwordx4 v8, s[24:27], s91 offen lds
    s_add_u32 m0, s67, 14336
    s_add_u32 s91, s66, 82048
    buffer_load_dwordx4 v8, s[24:27], s91 offen lds
    s_add_u32 m0, s67, 15360
    s_add_u32 s91, s66, 102400
    buffer_load_dwordx4 v8, s[24:27], s91 offen lds
    s_add_u32 m0, s67, 16384
    s_add_u32 s91, s66, 102464
    buffer_load_dwordx4 v8, s[24:27], s91 offen lds
    s_add_u32 m0, s67, 17408
    s_add_u32 s91, s66, 102528
    buffer_load_dwordx4 v8, s[24:27], s91 offen lds
    s_lshr_b32 s91, s69, 3
    s_lshl_b32 s91, s91, 2
    s_add_u32 s91, s91, s32
    s_mul_i32 s91, s91, 7360
    v_lshlrev_b32 v11, 6, v1
    buffer_load_dword v12, v11, s[80:83], s91 offen
    s_add_u32 s91, s91, 3264
    buffer_load_dword v12, v11, s[80:83], s91 offen
    s_cmp_lg_u32 s32, 0
    s_cbranch_scc1 main_polled
    s_mov_b64 exec, 1
main_poll:
    buffer_load_dword v226, v224, s[28:31], s93 offen sc1
    s_waitcnt vmcnt(0)
    v_readfirstlane_b32 s95, v226
    s_nop 0
    s_cmp_ge_u32 s95, 16
    s_cbranch_scc1 main_pdone
    s_sleep 8
    s_branch main_poll
main_pdone:
    s_mov_b64 exec, -1
main_polled:
    s_barrier
    s_setprio 0
    buffer_load_dwordx4 v[136:139], v5, s[28:31], s68 offen offset:0 sc1
    buffer_load_dwordx4 v[140:143], v5, s[28:31], s65 offen offset:0 sc1
    buffer_load_dwordx4 v[144:147], v5, s[28:31], s68 offen offset:1024 sc1
    buffer_load_dwordx4 v[148:151], v5, s[28:31], s65 offen offset:1024 sc1
    buffer_load_dwordx4 v[152:155], v5, s[28:31], s68 offen offset:2048 sc1
    buffer_load_dwordx4 v[156:159], v5, s[28:31], s65 offen offset:2048 sc1
    buffer_load_dwordx4 v[160:163], v5, s[28:31], s68 offen offset:3072 sc1
    buffer_load_dwordx4 v[164:167], v5, s[28:31], s65 offen offset:3072 sc1
    s_add_u32 s68, s68, 4096
    buffer_load_dwordx4 v[168:171], v5, s[28:31], s68 offen offset:0 sc1
    s_add_u32 s65, s65, 4096
    buffer_load_dwordx4 v[172:175], v5, s[28:31], s65 offen offset:0 sc1
    buffer_load_dwordx4 v[176:179], v5, s[28:31], s68 offen offset:1024 sc1
    buffer_load_dwordx4 v[180:183], v5, s[28:31], s65 offen offset:1024 sc1
    s_waitcnt vmcnt(10)
    ds_read_b64_tr_b16 v[112:113], v9 offset:0
    ds_read_b64_tr_b16 v[114:115], v9 offset:512
    ds_read_b64_tr_b16 v[116:117], v9 offset:1024
    ds_read_b64_tr_b16 v[118:119], v9 offset:1536
    ds_read_b64_tr_b16 v[120:121], v9 offset:2048
    ds_read_b64_tr_b16 v[122:123], v9 offset:2560
    s_waitcnt vmcnt(8)
    ds_read_b64_tr_b16 v[124:125], v9 offset:3072
    ds_read_b64_tr_b16 v[126:127], v9 offset:3584
    ds_read_b64_tr_b16 v[128:129], v9 offset:4096
    ds_read_b64_tr_b16 v[130:131], v9 offset:4608
    ds_read_b64_tr_b16 v[132:133], v9 offset:5120
    ds_read_b64_tr_b16 v[134:135], v9 offset:5632
    s_waitcnt lgkmcnt(6)
    v_mfma_f32_32x32x16_bf16 v[16:31], v[112:115], v[136:139], 0
    s_add_u32 m0, s67, 0
    s_add_u32 s91, s66, 122880
    buffer_load_dwordx4 v8, s[24:27], s91 offen lds
    v_mfma_f32_32x32x16_bf16 v[64:79], v[112:115], v[140:143], 0
    v_mfma_f32_32x32x16_bf16 v[32:47], v[116:119], v[136:139], 0
    s_add_u32 m0, s67, 1024
    s_add_u32 s91, s66, 122944
    buffer_load_dwordx4 v8, s[24:27], s91 offen lds
    v_mfma_f32_32x32x16_bf16 v[80:95], v[116:119], v[140:143], 0
    v_mfma_f32_32x32x16_bf16 v[48:63], v[120:123], v[136:139], 0
    s_add_u32 m0, s67, 2048
    s_add_u32 s91, s66, 123008
    buffer_load_dwordx4 v8, s[24:27], s91 offen lds
    v_mfma_f32_32x32x16_bf16 v[96:111], v[120:123], v[140:143], 0
    buffer_load_dwordx4 v[136:139], v5, s[28:31], s68 offen offset:2048 sc1
    buffer_load_dwordx4 v[140:143], v5, s[28:31], s65 offen offset:2048 sc1
    s_waitcnt vmcnt(11)
    ds_read_b64_tr_b16 v[112:113], v9 offset:6144
    ds_read_b64_tr_b16 v[114:115], v9 offset:6656
    ds_read_b64_tr_b16 v[116:117], v9 offset:7168
    ds_read_b64_tr_b16 v[118:119], v9 offset:7680
    ds_read_b64_tr_b16 v[120:121], v9 offset:8192
    ds_read_b64_tr_b16 v[122:123], v9 offset:8704
    s_waitcnt lgkmcnt(6)
    v_mfma_f32_32x32x16_bf16 v[16:31], v[124:127], v[144:147], v[16:31]
    s_add_u32 m0, s67, 3072
    s_add_u32 s91, s66, 143360
    buffer_load_dwordx4 v8, s[24:27], s91 offen lds
    v_mfma_f32_32x32x16_bf16 v[64:79], v[124:127], v[148:151], v[64:79]
    v_mfma_f32_32x32x16_bf16 v[32:47], v[128:131], v[144:147], v[32:47]
    s_add_u32 m0, s67, 4096
    s_add_u32 s91, s66, 143424
    buffer_load_dwordx4 v8, s[24:27], s91 offen lds
    v_mfma_f32_32x32x16_bf16 v[80:95], v[128:131], v[148:151], v[80:95]
    v_mfma_f32_32x32x16_bf16 v[48:63], v[132:135], v[144:147], v[48:63]
    s_add_u32 m0, s67, 5120
    s_add_u32 s91, s66, 143488
    buffer_load_dwordx4 v8, s[24:27], s91 offen lds
    v_mfma_f32_32x32x16_bf16 v[96:111], v[132:135], v[148:151], v[96:111]
    buffer_load_dwordx4 v[144:147], v5, s[28:31], s68 offen offset:3072 sc1
    buffer_load_dwordx4 v[148:151], v5, s[28:31], s65 offen offset:3072 sc1
    s_waitcnt vmcnt(14)
    ds_read_b64_tr_b16 v[124:125], v9 offset:9216
    ds_read_b64_tr_b16 v[126:127], v9 offset:9728
    ds_read_b64_tr_b16 v[128:129], v9 offset:10240
    ds_read_b64_tr_b16 v[130:131], v9 offset:10752
    ds_read_b64_tr_b16 v[132:133], v9 offset:11264
    ds_read_b64_tr_b16 v[134:135], v9 offset:11776
    s_waitcnt lgkmcnt(6)
    v_mfma_f32_32x32x16_bf16 v[16:31], v[112:115], v[152:155], v[16:31]
    s_add_u32 m0, s67, 6144
    s_add_u32 s91, s66, 163840
    buffer_load_dwordx4 v8, s[24:27], s91 offen lds
    v_mfma_f32_32x32x16_bf16 v[64:79], v[112:115], v[156:159], v[64:79]
    v_mfma_f32_32x32x16_bf16 v[32:47], v[116:119], v[152:155], v[32:47]
    s_add_u32 m0, s67, 7168
    s_add_u32 s91, s66, 163904
    buffer_load_dwordx4 v8, s[24:27], s91 offen lds
    v_mfma_f32_32x32x16_bf16 v[80:95], v[116:119], v[156:159], v[80:95]
    v_mfma_f32_32x32x16_bf16 v[48:63], v[120:123], v[152:155], v[48:63]
    s_add_u32 m0, s67, 8192
    s_add_u32 s91, s66, 163968
    buffer_load_dwordx4 v8, s[24:27], s91 offen lds
    v_mfma_f32_32x32x16_bf16 v[96:111], v[120:123], v[156:159], v[96:111]
    s_add_u32 s68, s68, 4096
    buffer_load_dwordx4 v[152:155], v5, s[28:31], s68 offen offset:0 sc1
    s_add_u32 s65, s65, 4096
    buffer_load_dwordx4 v[156:159], v5, s[28:31], s65 offen offset:0 sc1
    s_waitcnt vmcnt(17)
    ds_read_b64_tr_b16 v[112:113], v9 offset:12288
    ds_read_b64_tr_b16 v[114:115], v9 offset:12800
    ds_read_b64_tr_b16 v[116:117], v9 offset:13312
    ds_read_b64_tr_b16 v[118:119], v9 offset:13824
    ds_read_b64_tr_b16 v[120:121], v9 offset:14336
    ds_read_b64_tr_b16 v[122:123], v9 offset:14848
    s_waitcnt lgkmcnt(6)
    v_mfma_f32_32x32x16_bf16 v[16:31], v[124:127], v[160:163], v[16:31]
    s_add_u32 m0, s67, 9216
    s_add_u32 s91, s66, 184320
    buffer_load_dwordx4 v8, s[24:27], s91 offen lds
    v_mfma_f32_32x32x16_bf16 v[64:79], v[124:127], v[164:167], v[64:79]
    v_mfma_f32_32x32x16_bf16 v[32:47], v[128:131], v[160:163], v[32:47]
    s_add_u32 m0, s67, 10240
    s_add_u32 s91, s66, 184384
    buffer_load_dwordx4 v8, s[24:27], s91 offen lds
    v_mfma_f32_32x32x16_bf16 v[80:95], v[128:131], v[164:167], v[80:95]
    v_mfma_f32_32x32x16_bf16 v[48:63], v[132:135], v[160:163], v[48:63]
    s_add_u32 m0, s67, 11264
    s_add_u32 s91, s66, 184448
    buffer_load_dwordx4 v8, s[24:27], s91 offen lds
    v_mfma_f32_32x32x16_bf16 v[96:111], v[132:135], v[164:167], v[96:111]
    buffer_load_dwordx4 v[160:163], v5, s[28:31], s68 offen offset:1024 sc1
    buffer_load_dwordx4 v[164:167], v5, s[28:31], s65 offen offset:1024 sc1
    s_waitcnt vmcnt(20)
    ds_read_b64_tr_b16 v[124:125], v9 offset:15360
    ds_read_b64_tr_b16 v[126:127], v9 offset:15872
    ds_read_b64_tr_b16 v[128:129], v9 offset:16384
    ds_read_b64_tr_b16 v[130:131], v9 offset:16896
    ds_read_b64_tr_b16 v[132:133], v9 offset:17408
    ds_read_b64_tr_b16 v[134:135], v9 offset:17920
    s_waitcnt lgkmcnt(6)
    v_mfma_f32_32x32x16_bf16 v[16:31], v[112:115], v[168:171], v[16:31]
    s_add_u32 m0, s67, 12288
    s_add_u32 s91, s66, 204800
    buffer_load_dwordx4 v8, s[24:27], s91 offen lds
    v_mfma_f32_32x32x16_bf16 v[64:79], v[112:115], v[172:175], v[64:79]
    v_mfma_f32_32x32x16_bf16 v[32:47], v[116:119], v[168:171], v[32:47]
    s_add_u32 m0, s67, 13312
    s_add_u32 s91, s66, 204864
    buffer_load_dwordx4 v8, s[24:27], s91 offen lds
    v_mfma_f32_32x32x16_bf16 v[80:95], v[116:119], v[172:175], v[80:95]
    v_mfma_f32_32x32x16_bf16 v[48:63], v[120:123], v[168:171], v[48:63]
    s_add_u32 m0, s67, 14336
    s_add_u32 s91, s66, 204928
    buffer_load_dwordx4 v8, s[24:27], s91 offen lds
    v_mfma_f32_32x32x16_bf16 v[96:111], v[120:123], v[172:175], v[96:111]
    buffer_load_dwordx4 v[168:171], v5, s[28:31], s68 offen offset:2048 sc1
    buffer_load_dwordx4 v[172:175], v5, s[28:31], s65 offen offset:2048 sc1
    s_waitcnt vmcnt(20)
    ds_read_b64_tr_b16 v[112:113], v9 offset:0
    ds_read_b64_tr_b16 v[114:115], v9 offset:512
    ds_read_b64_tr_b16 v[116:117], v9 offset:1024
    ds_read_b64_tr_b16 v[118:119], v9 offset:1536
    ds_read_b64_tr_b16 v[120:121], v9 offset:2048
    ds_read_b64_tr_b16 v[122:123], v9 offset:2560
    s_waitcnt lgkmcnt(6)
    v_mfma_f32_32x32x16_bf16 v[16:31], v[124:127], v[176:179], v[16:31]
    s_add_u32 m0, s67, 15360
    s_add_u32 s91, s66, 225280
    buffer_load_dwordx4 v8, s[24:27], s91 offen lds
    v_mfma_f32_32x32x16_bf16 v[64:79], v[124:127], v[180:183], v[64:79]
    v_mfma_f32_32x32x16_bf16 v[32:47], v[128:131], v[176:179], v[32:47]
    s_add_u32 m0, s67, 16384
    s_add_u32 s91, s66, 225344
    buffer_load_dwordx4 v8, s[24:27], s91 offen lds
    v_mfma_f32_32x32x16_bf16 v[80:95], v[128:131], v[180:183], v[80:95]
    v_mfma_f32_32x32x16_bf16 v[48:63], v[132:135], v[176:179], v[48:63]
    s_add_u32 m0, s67, 17408
    s_add_u32 s91, s66, 225408
    buffer_load_dwordx4 v8, s[24:27], s91 offen lds
    v_mfma_f32_32x32x16_bf16 v[96:111], v[132:135], v[180:183], v[96:111]
    buffer_load_dwordx4 v[176:179], v5, s[28:31], s68 offen offset:3072 sc1
    buffer_load_dwordx4 v[180:183], v5, s[28:31], s65 offen offset:3072 sc1
    s_waitcnt vmcnt(20)
    ds_read_b64_tr_b16 v[124:125], v9 offset:3072
    ds_read_b64_tr_b16 v[126:127], v9 offset:3584
    ds_read_b64_tr_b16 v[128:129], v9 offset:4096
    ds_read_b64_tr_b16 v[130:131], v9 offset:4608
    ds_read_b64_tr_b16 v[132:133], v9 offset:5120
    ds_read_b64_tr_b16 v[134:135], v9 offset:5632
    s_waitcnt lgkmcnt(6)
    v_mfma_f32_32x32x16_bf16 v[16:31], v[112:115], v[136:139], v[16:31]
    s_add_u32 m0, s67, 0
    s_add_u32 s91, s66, 245760
    buffer_load_dwordx4 v8, s[24:27], s91 offen lds
    v_mfma_f32_32x32x16_bf16 v[64:79], v[112:115], v[140:143], v[64:79]
    v_mfma_f32_32x32x16_bf16 v[32:47], v[116:119], v[136:139], v[32:47]
    s_add_u32 m0, s67, 1024
    s_add_u32 s91, s66, 245824
    buffer_load_dwordx4 v8, s[24:27], s91 offen lds
    v_mfma_f32_32x32x16_bf16 v[80:95], v[116:119], v[140:143], v[80:95]
    v_mfma_f32_32x32x16_bf16 v[48:63], v[120:123], v[136:139], v[48:63]
    s_add_u32 m0, s67, 2048
    s_add_u32 s91, s66, 245888
    buffer_load_dwordx4 v8, s[24:27], s91 offen lds
    v_mfma_f32_32x32x16_bf16 v[96:111], v[120:123], v[140:143], v[96:111]
    s_add_u32 s68, s68, 4096
    buffer_load_dwordx4 v[136:139], v5, s[28:31], s68 offen offset:0 sc1
    s_add_u32 s65, s65, 4096
    buffer_load_dwordx4 v[140:143], v5, s[28:31], s65 offen offset:0 sc1
    s_waitcnt vmcnt(20)
    ds_read_b64_tr_b16 v[112:113], v9 offset:6144
    ds_read_b64_tr_b16 v[114:115], v9 offset:6656
    ds_read_b64_tr_b16 v[116:117], v9 offset:7168
    ds_read_b64_tr_b16 v[118:119], v9 offset:7680
    ds_read_b64_tr_b16 v[120:121], v9 offset:8192
    ds_read_b64_tr_b16 v[122:123], v9 offset:8704
    s_waitcnt lgkmcnt(6)
    v_mfma_f32_32x32x16_bf16 v[16:31], v[124:127], v[144:147], v[16:31]
    s_add_u32 m0, s67, 3072
    s_add_u32 s91, s66, 266240
    buffer_load_dwordx4 v8, s[24:27], s91 offen lds
    v_mfma_f32_32x32x16_bf16 v[64:79], v[124:127], v[148:151], v[64:79]
    v_mfma_f32_32x32x16_bf16 v[32:47], v[128:131], v[144:147], v[32:47]
    s_add_u32 m0, s67, 4096
    s_add_u32 s91, s66, 266304
    buffer_load_dwordx4 v8, s[24:27], s91 offen lds
    v_mfma_f32_32x32x16_bf16 v[80:95], v[128:131], v[148:151], v[80:95]
    v_mfma_f32_32x32x16_bf16 v[48:63], v[132:135], v[144:147], v[48:63]
    s_add_u32 m0, s67, 5120
    s_add_u32 s91, s66, 266368
    buffer_load_dwordx4 v8, s[24:27], s91 offen lds
    v_mfma_f32_32x32x16_bf16 v[96:111], v[132:135], v[148:151], v[96:111]
    buffer_load_dwordx4 v[144:147], v5, s[28:31], s68 offen offset:1024 sc1
    buffer_load_dwordx4 v[148:151], v5, s[28:31], s65 offen offset:1024 sc1
    s_waitcnt vmcnt(20)
    ds_read_b64_tr_b16 v[124:125], v9 offset:9216
    ds_read_b64_tr_b16 v[126:127], v9 offset:9728
    ds_read_b64_tr_b16 v[128:129], v9 offset:10240
    ds_read_b64_tr_b16 v[130:131], v9 offset:10752
    ds_read_b64_tr_b16 v[132:133], v9 offset:11264
    ds_read_b64_tr_b16 v[134:135], v9 offset:11776
    s_waitcnt lgkmcnt(6)
    v_mfma_f32_32x32x16_bf16 v[16:31], v[112:115], v[152:155], v[16:31]
    s_add_u32 m0, s67, 6144
    s_add_u32 s91, s66, 286720
    buffer_load_dwordx4 v8, s[24:27], s91 offen lds
    v_mfma_f32_32x32x16_bf16 v[64:79], v[112:115], v[156:159], v[64:79]
    v_mfma_f32_32x32x16_bf16 v[32:47], v[116:119], v[152:155], v[32:47]
    s_add_u32 m0, s67, 7168
    s_add_u32 s91, s66, 286784
    buffer_load_dwordx4 v8, s[24:27], s91 offen lds
    v_mfma_f32_32x32x16_bf16 v[80:95], v[116:119], v[156:159], v[80:95]
    v_mfma_f32_32x32x16_bf16 v[48:63], v[120:123], v[152:155], v[48:63]
    s_add_u32 m0, s67, 8192
    s_add_u32 s91, s66, 286848
    buffer_load_dwordx4 v8, s[24:27], s91 offen lds
    v_mfma_f32_32x32x16_bf16 v[96:111], v[120:123], v[156:159], v[96:111]
    buffer_load_dwordx4 v[152:155], v5, s[28:31], s68 offen offset:2048 sc1
    buffer_load_dwordx4 v[156:159], v5, s[28:31], s65 offen offset:2048 sc1
    s_waitcnt vmcnt(20)
    ds_read_b64_tr_b16 v[112:113], v9 offset:12288
    ds_read_b64_tr_b16 v[114:115], v9 offset:12800
    ds_read_b64_tr_b16 v[116:117], v9 offset:13312
    ds_read_b64_tr_b16 v[118:119], v9 offset:13824
    ds_read_b64_tr_b16 v[120:121], v9 offset:14336
    ds_read_b64_tr_b16 v[122:123], v9 offset:14848
    s_waitcnt lgkmcnt(6)
    v_mfma_f32_32x32x16_bf16 v[16:31], v[124:127], v[160:163], v[16:31]
    s_add_u32 m0, s67, 9216
    s_add_u32 s91, s66, 307200
    buffer_load_dwordx4 v8, s[24:27], s91 offen lds
    v_mfma_f32_32x32x16_bf16 v[64:79], v[124:127], v[164:167], v[64:79]
    v_mfma_f32_32x32x16_bf16 v[32:47], v[128:131], v[160:163], v[32:47]
    s_add_u32 m0, s67, 10240
    s_add_u32 s91, s66, 307264
    buffer_load_dwordx4 v8, s[24:27], s91 offen lds
    v_mfma_f32_32x32x16_bf16 v[80:95], v[128:131], v[164:167], v[80:95]
    v_mfma_f32_32x32x16_bf16 v[48:63], v[132:135], v[160:163], v[48:63]
    s_add_u32 m0, s67, 11264
    s_add_u32 s91, s66, 307328
    buffer_load_dwordx4 v8, s[24:27], s91 offen lds
    v_mfma_f32_32x32x16_bf16 v[96:111], v[132:135], v[164:167], v[96:111]
    buffer_load_dwordx4 v[160:163], v5, s[28:31], s68 offen offset:3072 sc1
    buffer_load_dwordx4 v[164:167], v5, s[28:31], s65 offen offset:3072 sc1
    s_waitcnt vmcnt(20)
    ds_read_b64_tr_b16 v[124:125], v9 offset:15360
    ds_read_b64_tr_b16 v[126:127], v9 offset:15872
    ds_read_b64_tr_b16 v[128:129], v9 offset:16384
    ds_read_b64_tr_b16 v[130:131], v9 offset:16896
    ds_read_b64_tr_b16 v[132:133], v9 offset:17408
    ds_read_b64_tr_b16 v[134:135], v9 offset:17920
    s_waitcnt lgkmcnt(6)
    v_mfma_f32_32x32x16_bf16 v[16:31], v[112:115], v[168:171], v[16:31]
    s_add_u32 m0, s67, 12288
    s_add_u32 s91, s66, 327680
    buffer_load_dwordx4 v8, s[24:27], s91 offen lds
    v_mfma_f32_32x32x16_bf16 v[64:79], v[112:115], v[172:175], v[64:79]
    v_mfma_f32_32x32x16_bf16 v[32:47], v[116:119], v[168:171], v[32:47]
    s_add_u32 m0, s67, 13312
    s_add_u32 s91, s66, 327744
    buffer_load_dwordx4 v8, s[24:27], s91 offen lds
    v_mfma_f32_32x32x16_bf16 v[80:95], v[116:119], v[172:175], v[80:95]
    v_mfma_f32_32x32x16_bf16 v[48:63], v[120:123], v[168:171], v[48:63]
    s_add_u32 m0, s67, 14336
    s_add_u32 s91, s66, 327808
    buffer_load_dwordx4 v8, s[24:27], s91 offen lds
    v_mfma_f32_32x32x16_bf16 v[96:111], v[120:123], v[172:175], v[96:111]
    s_add_u32 s68, s68, 4096
    buffer_load_dwordx4 v[168:171], v5, s[28:31], s68 offen offset:0 sc1
    s_add_u32 s65, s65, 4096
    buffer_load_dwordx4 v[172:175], v5, s[28:31], s65 offen offset:0 sc1
    s_waitcnt vmcnt(20)
    ds_read_b64_tr_b16 v[112:113], v9 offset:0
    ds_read_b64_tr_b16 v[114:115], v9 offset:512
    ds_read_b64_tr_b16 v[116:117], v9 offset:1024
    ds_read_b64_tr_b16 v[118:119], v9 offset:1536
    ds_read_b64_tr_b16 v[120:121], v9 offset:2048
    ds_read_b64_tr_b16 v[122:123], v9 offset:2560
    s_waitcnt lgkmcnt(6)
    v_mfma_f32_32x32x16_bf16 v[16:31], v[124:127], v[176:179], v[16:31]
    s_add_u32 m0, s67, 15360
    s_add_u32 s91, s66, 348160
    buffer_load_dwordx4 v8, s[24:27], s91 offen lds
    v_mfma_f32_32x32x16_bf16 v[64:79], v[124:127], v[180:183], v[64:79]
    v_mfma_f32_32x32x16_bf16 v[32:47], v[128:131], v[176:179], v[32:47]
    s_add_u32 m0, s67, 16384
    s_add_u32 s91, s66, 348224
    buffer_load_dwordx4 v8, s[24:27], s91 offen lds
    v_mfma_f32_32x32x16_bf16 v[80:95], v[128:131], v[180:183], v[80:95]
    v_mfma_f32_32x32x16_bf16 v[48:63], v[132:135], v[176:179], v[48:63]
    s_add_u32 m0, s67, 17408
    s_add_u32 s91, s66, 348288
    buffer_load_dwordx4 v8, s[24:27], s91 offen lds
    v_mfma_f32_32x32x16_bf16 v[96:111], v[132:135], v[180:183], v[96:111]
    buffer_load_dwordx4 v[176:179], v5, s[28:31], s68 offen offset:1024 sc1
    buffer_load_dwordx4 v[180:183], v5, s[28:31], s65 offen offset:1024 sc1
    s_waitcnt vmcnt(20)
    ds_read_b64_tr_b16 v[124:125], v9 offset:3072
    ds_read_b64_tr_b16 v[126:127], v9 offset:3584
    ds_read_b64_tr_b16 v[128:129], v9 offset:4096
    ds_read_b64_tr_b16 v[130:131], v9 offset:4608
    ds_read_b64_tr_b16 v[132:133], v9 offset:5120
    ds_read_b64_tr_b16 v[134:135], v9 offset:5632
    s_waitcnt lgkmcnt(6)
    v_mfma_f32_32x32x16_bf16 v[16:31], v[112:115], v[136:139], v[16:31]
    s_add_u32 m0, s67, 0
    s_add_u32 s91, s66, 368640
    buffer_load_dwordx4 v8, s[24:27], s91 offen lds
    v_mfma_f32_32x32x16_bf16 v[64:79], v[112:115], v[140:143], v[64:79]
    v_mfma_f32_32x32x16_bf16 v[32:47], v[116:119], v[136:139], v[32:47]
    s_add_u32 m0, s67, 1024
    s_add_u32 s91, s66, 368704
    buffer_load_dwordx4 v8, s[24:27], s91 offen lds
    v_mfma_f32_32x32x16_bf16 v[80:95], v[116:119], v[140:143], v[80:95]
    v_mfma_f32_32x32x16_bf16 v[48:63], v[120:123], v[136:139], v[48:63]
    s_add_u32 m0, s67, 2048
    s_add_u32 s91, s66, 368768
    buffer_load_dwordx4 v8, s[24:27], s91 offen lds
    v_mfma_f32_32x32x16_bf16 v[96:111], v[120:123], v[140:143], v[96:111]
    buffer_load_dwordx4 v[136:139], v5, s[28:31], s68 offen offset:2048 sc1
    buffer_load_dwordx4 v[140:143], v5, s[28:31], s65 offen offset:2048 sc1
    s_waitcnt vmcnt(20)
    ds_read_b64_tr_b16 v[112:113], v9 offset:6144
    ds_read_b64_tr_b16 v[114:115], v9 offset:6656
    ds_read_b64_tr_b16 v[116:117], v9 offset:7168
    ds_read_b64_tr_b16 v[118:119], v9 offset:7680
    ds_read_b64_tr_b16 v[120:121], v9 offset:8192
    ds_read_b64_tr_b16 v[122:123], v9 offset:8704
    s_waitcnt lgkmcnt(6)
    v_mfma_f32_32x32x16_bf16 v[16:31], v[124:127], v[144:147], v[16:31]
    s_add_u32 m0, s67, 3072
    s_add_u32 s91, s66, 389120
    buffer_load_dwordx4 v8, s[24:27], s91 offen lds
    v_mfma_f32_32x32x16_bf16 v[64:79], v[124:127], v[148:151], v[64:79]
    v_mfma_f32_32x32x16_bf16 v[32:47], v[128:131], v[144:147], v[32:47]
    s_add_u32 m0, s67, 4096
    s_add_u32 s91, s66, 389184
    buffer_load_dwordx4 v8, s[24:27], s91 offen lds
    v_mfma_f32_32x32x16_bf16 v[80:95], v[128:131], v[148:151], v[80:95]
    v_mfma_f32_32x32x16_bf16 v[48:63], v[132:135], v[144:147], v[48:63]
    s_add_u32 m0, s67, 5120
    s_add_u32 s91, s66, 389248
    buffer_load_dwordx4 v8, s[24:27], s91 offen lds
    v_mfma_f32_32x32x16_bf16 v[96:111], v[132:135], v[148:151], v[96:111]
    buffer_load_dwordx4 v[144:147], v5, s[28:31], s68 offen offset:3072 sc1
    buffer_load_dwordx4 v[148:151], v5, s[28:31], s65 offen offset:3072 sc1
    s_waitcnt vmcnt(20)
    ds_read_b64_tr_b16 v[124:125], v9 offset:9216
    ds_read_b64_tr_b16 v[126:127], v9 offset:9728
    ds_read_b64_tr_b16 v[128:129], v9 offset:10240
    ds_read_b64_tr_b16 v[130:131], v9 offset:10752
    ds_read_b64_tr_b16 v[132:133], v9 offset:11264
    ds_read_b64_tr_b16 v[134:135], v9 offset:11776
    s_waitcnt lgkmcnt(6)
    v_mfma_f32_32x32x16_bf16 v[16:31], v[112:115], v[152:155], v[16:31]
    s_add_u32 m0, s67, 6144
    s_add_u32 s91, s66, 409600
    buffer_load_dwordx4 v8, s[24:27], s91 offen lds
    v_mfma_f32_32x32x16_bf16 v[64:79], v[112:115], v[156:159], v[64:79]
    v_mfma_f32_32x32x16_bf16 v[32:47], v[116:119], v[152:155], v[32:47]
    s_add_u32 m0, s67, 7168
    s_add_u32 s91, s66, 409664
    buffer_load_dwordx4 v8, s[24:27], s91 offen lds
    v_mfma_f32_32x32x16_bf16 v[80:95], v[116:119], v[156:159], v[80:95]
    v_mfma_f32_32x32x16_bf16 v[48:63], v[120:123], v[152:155], v[48:63]
    s_add_u32 m0, s67, 8192
    s_add_u32 s91, s66, 409728
    buffer_load_dwordx4 v8, s[24:27], s91 offen lds
    v_mfma_f32_32x32x16_bf16 v[96:111], v[120:123], v[156:159], v[96:111]
    s_add_u32 s68, s68, 4096
    buffer_load_dwordx4 v[152:155], v5, s[28:31], s68 offen offset:0 sc1
    s_add_u32 s65, s65, 4096
    buffer_load_dwordx4 v[156:159], v5, s[28:31], s65 offen offset:0 sc1
    s_waitcnt vmcnt(20)
    ds_read_b64_tr_b16 v[112:113], v9 offset:12288
    ds_read_b64_tr_b16 v[114:115], v9 offset:12800
    ds_read_b64_tr_b16 v[116:117], v9 offset:13312
    ds_read_b64_tr_b16 v[118:119], v9 offset:13824
    ds_read_b64_tr_b16 v[120:121], v9 offset:14336
    ds_read_b64_tr_b16 v[122:123], v9 offset:14848
    s_waitcnt lgkmcnt(6)
    v_mfma_f32_32x32x16_bf16 v[16:31], v[124:127], v[160:163], v[16:31]
    s_add_u32 m0, s67, 9216
    s_add_u32 s91, s66, 430080
    buffer_load_dwordx4 v8, s[24:27], s91 offen lds
    v_mfma_f32_32x32x16_bf16 v[64:79], v[124:127], v[164:167], v[64:79]
    v_mfma_f32_32x32x16_bf16 v[32:47], v[128:131], v[160:163], v[32:47]
    s_add_u32 m0, s67, 10240
    s_add_u32 s91, s66, 430144
    buffer_load_dwordx4 v8, s[24:27], s91 offen lds
    v_mfma_f32_32x32x16_bf16 v[80:95], v[128:131], v[164:167], v[80:95]
    v_mfma_f32_32x32x16_bf16 v[48:63], v[132:135], v[160:163], v[48:63]
    s_add_u32 m0, s67, 11264
    s_add_u32 s91, s66, 430208
    buffer_load_dwordx4 v8, s[24:27], s91 offen lds
    v_mfma_f32_32x32x16_bf16 v[96:111], v[132:135], v[164:167], v[96:111]
    buffer_load_dwordx4 v[160:163], v5, s[28:31], s68 offen offset:1024 sc1
    buffer_load_dwordx4 v[164:167], v5, s[28:31], s65 offen offset:1024 sc1
    s_waitcnt vmcnt(20)
    ds_read_b64_tr_b16 v[124:125], v9 offset:15360
    ds_read_b64_tr_b16 v[126:127], v9 offset:15872
    ds_read_b64_tr_b16 v[128:129], v9 offset:16384
    ds_read_b64_tr_b16 v[130:131], v9 offset:16896
    ds_read_b64_tr_b16 v[132:133], v9 offset:17408
    ds_read_b64_tr_b16 v[134:135], v9 offset:17920
    s_waitcnt lgkmcnt(6)
    v_mfma_f32_32x32x16_bf16 v[16:31], v[112:115], v[168:171], v[16:31]
    s_add_u32 m0, s67, 12288
    s_add_u32 s91, s66, 450560
    buffer_load_dwordx4 v8, s[24:27], s91 offen lds
    v_mfma_f32_32x32x16_bf16 v[64:79], v[112:115], v[172:175], v[64:79]
    v_mfma_f32_32x32x16_bf16 v[32:47], v[116:119], v[168:171], v[32:47]
    s_add_u32 m0, s67, 13312
    s_add_u32 s91, s66, 450624
    buffer_load_dwordx4 v8, s[24:27], s91 offen lds
    v_mfma_f32_32x32x16_bf16 v[80:95], v[116:119], v[172:175], v[80:95]
    v_mfma_f32_32x32x16_bf16 v[48:63], v[120:123], v[168:171], v[48:63]
    s_add_u32 m0, s67, 14336
    s_add_u32 s91, s66, 450688
    buffer_load_dwordx4 v8, s[24:27], s91 offen lds
    v_mfma_f32_32x32x16_bf16 v[96:111], v[120:123], v[172:175], v[96:111]
    buffer_load_dwordx4 v[168:171], v5, s[28:31], s68 offen offset:2048 sc1
    buffer_load_dwordx4 v[172:175], v5, s[28:31], s65 offen offset:2048 sc1
    s_waitcnt vmcnt(20)
    ds_read_b64_tr_b16 v[112:113], v9 offset:0
    ds_read_b64_tr_b16 v[114:115], v9 offset:512
    ds_read_b64_tr_b16 v[116:117], v9 offset:1024
    ds_read_b64_tr_b16 v[118:119], v9 offset:1536
    ds_read_b64_tr_b16 v[120:121], v9 offset:2048
    ds_read_b64_tr_b16 v[122:123], v9 offset:2560
    s_waitcnt lgkmcnt(6)
    v_mfma_f32_32x32x16_bf16 v[16:31], v[124:127], v[176:179], v[16:31]
    s_add_u32 m0, s67, 15360
    s_add_u32 s91, s66, 471040
    buffer_load_dwordx4 v8, s[24:27], s91 offen lds
    v_mfma_f32_32x32x16_bf16 v[64:79], v[124:127], v[180:183], v[64:79]
    v_mfma_f32_32x32x16_bf16 v[32:47], v[128:131], v[176:179], v[32:47]
    s_add_u32 m0, s67, 16384
    s_add_u32 s91, s66, 471104
    buffer_load_dwordx4 v8, s[24:27], s91 offen lds
    v_mfma_f32_32x32x16_bf16 v[80:95], v[128:131], v[180:183], v[80:95]
    v_mfma_f32_32x32x16_bf16 v[48:63], v[132:135], v[176:179], v[48:63]
    s_add_u32 m0, s67, 17408
    s_add_u32 s91, s66, 471168
    buffer_load_dwordx4 v8, s[24:27], s91 offen lds
    v_mfma_f32_32x32x16_bf16 v[96:111], v[132:135], v[180:183], v[96:111]
    buffer_load_dwordx4 v[176:179], v5, s[28:31], s68 offen offset:3072 sc1
    buffer_load_dwordx4 v[180:183], v5, s[28:31], s65 offen offset:3072 sc1
    s_waitcnt vmcnt(20)
    ds_read_b64_tr_b16 v[124:125], v9 offset:3072
    ds_read_b64_tr_b16 v[126:127], v9 offset:3584
    ds_read_b64_tr_b16 v[128:129], v9 offset:4096
    ds_read_b64_tr_b16 v[130:131], v9 offset:4608
    ds_read_b64_tr_b16 v[132:133], v9 offset:5120
    ds_read_b64_tr_b16 v[134:135], v9 offset:5632
    s_waitcnt lgkmcnt(6)
    v_mfma_f32_32x32x16_bf16 v[16:31], v[112:115], v[136:139], v[16:31]
    v_mfma_f32_32x32x16_bf16 v[64:79], v[112:115], v[140:143], v[64:79]
    v_mfma_f32_32x32x16_bf16 v[32:47], v[116:119], v[136:139], v[32:47]
    v_mfma_f32_32x32x16_bf16 v[80:95], v[116:119], v[140:143], v[80:95]
    v_mfma_f32_32x32x16_bf16 v[48:63], v[120:123], v[136:139], v[48:63]
    v_mfma_f32_32x32x16_bf16 v[96:111], v[120:123], v[140:143], v[96:111]
    s_waitcnt vmcnt(15)
    ds_read_b64_tr_b16 v[112:113], v9 offset:6144
    ds_read_b64_tr_b16 v[114:115], v9 offset:6656
    ds_read_b64_tr_b16 v[116:117], v9 offset:7168
    ds_read_b64_tr_b16 v[118:119], v9 offset:7680
    ds_read_b64_tr_b16 v[120:121], v9 offset:8192
    ds_read_b64_tr_b16 v[122:123], v9 offset:8704
    s_waitcnt lgkmcnt(6)
    v_mfma_f32_32x32x16_bf16 v[16:31], v[124:127], v[144:147], v[16:31]
    v_mfma_f32_32x32x16_bf16 v[64:79], v[124:127], v[148:151], v[64:79]
    v_mfma_f32_32x32x16_bf16 v[32:47], v[128:131], v[144:147], v[32:47]
    v_mfma_f32_32x32x16_bf16 v[80:95], v[128:131], v[148:151], v[80:95]
    v_mfma_f32_32x32x16_bf16 v[48:63], v[132:135], v[144:147], v[48:63]
    v_mfma_f32_32x32x16_bf16 v[96:111], v[132:135], v[148:151], v[96:111]
    s_waitcnt vmcnt(10)
    ds_read_b64_tr_b16 v[124:125], v9 offset:9216
    ds_read_b64_tr_b16 v[126:127], v9 offset:9728
    ds_read_b64_tr_b16 v[128:129], v9 offset:10240
    ds_read_b64_tr_b16 v[130:131], v9 offset:10752
    ds_read_b64_tr_b16 v[132:133], v9 offset:11264
    ds_read_b64_tr_b16 v[134:135], v9 offset:11776
    s_waitcnt lgkmcnt(6)
    v_mfma_f32_32x32x16_bf16 v[16:31], v[112:115], v[152:155], v[16:31]
    v_mfma_f32_32x32x16_bf16 v[64:79], v[112:115], v[156:159], v[64:79]
    v_mfma_f32_32x32x16_bf16 v[32:47], v[116:119], v[152:155], v[32:47]
    v_mfma_f32_32x32x16_bf16 v[80:95], v[116:119], v[156:159], v[80:95]
    v_mfma_f32_32x32x16_bf16 v[48:63], v[120:123], v[152:155], v[48:63]
    v_mfma_f32_32x32x16_bf16 v[96:111], v[120:123], v[156:159], v[96:111]
    s_waitcnt vmcnt(5)
    ds_read_b64_tr_b16 v[112:113], v9 offset:12288
    ds_read_b64_tr_b16 v[114:115], v9 offset:12800
    ds_read_b64_tr_b16 v[116:117], v9 offset:13312
    ds_read_b64_tr_b16 v[118:119], v9 offset:13824
    ds_read_b64_tr_b16 v[120:121], v9 offset:14336
    ds_read_b64_tr_b16 v[122:123], v9 offset:14848
    s_waitcnt lgkmcnt(6)
    v_mfma_f32_32x32x16_bf16 v[16:31], v[124:127], v[160:163], v[16:31]
    v_mfma_f32_32x32x16_bf16 v[64:79], v[124:127], v[164:167], v[64:79]
    v_mfma_f32_32x32x16_bf16 v[32:47], v[128:131], v[160:163], v[32:47]
    v_mfma_f32_32x32x16_bf16 v[80:95], v[128:131], v[164:167], v[80:95]
    v_mfma_f32_32x32x16_bf16 v[48:63], v[132:135], v[160:163], v[48:63]
    v_mfma_f32_32x32x16_bf16 v[96:111], v[132:135], v[164:167], v[96:111]
    s_waitcnt vmcnt(0)
    ds_read_b64_tr_b16 v[124:125], v9 offset:15360
    ds_read_b64_tr_b16 v[126:127], v9 offset:15872
    ds_read_b64_tr_b16 v[128:129], v9 offset:16384
    ds_read_b64_tr_b16 v[130:131], v9 offset:16896
    ds_read_b64_tr_b16 v[132:133], v9 offset:17408
    ds_read_b64_tr_b16 v[134:135], v9 offset:17920
    s_waitcnt lgkmcnt(6)
    v_mfma_f32_32x32x16_bf16 v[16:31], v[112:115], v[168:171], v[16:31]
    v_mfma_f32_32x32x16_bf16 v[64:79], v[112:115], v[172:175], v[64:79]
    v_mfma_f32_32x32x16_bf16 v[32:47], v[116:119], v[168:171], v[32:47]
    v_mfma_f32_32x32x16_bf16 v[80:95], v[116:119], v[172:175], v[80:95]
    v_mfma_f32_32x32x16_bf16 v[48:63], v[120:123], v[168:171], v[48:63]
    v_mfma_f32_32x32x16_bf16 v[96:111], v[120:123], v[172:175], v[96:111]
    s_waitcnt lgkmcnt(0)
    v_mfma_f32_32x32x16_bf16 v[16:31], v[124:127], v[176:179], v[16:31]
    v_mfma_f32_32x32x16_bf16 v[64:79], v[124:127], v[180:183], v[64:79]
    v_mfma_f32_32x32x16_bf16 v[32:47], v[128:131], v[176:179], v[32:47]
    v_mfma_f32_32x32x16_bf16 v[80:95], v[128:131], v[180:183], v[80:95]
    v_mfma_f32_32x32x16_bf16 v[48:63], v[132:135], v[176:179], v[48:63]
    v_mfma_f32_32x32x16_bf16 v[96:111], v[132:135], v[180:183], v[96:111]
    s_and_b32 s45, s32, 1
    s_lshr_b32 s46, s32, 1
    s_setprio 0
    s_cmp_eq_u32 s32, 0
    s_cbranch_scc1 t2_w0
    s_sub_u32 s91, 3, s32
    s_and_b32 s91, s91, 3
    s_mul_i32 s91, s91, 6144
    s_add_u32 s91, s91, s67
    v_add_u32 v224, s91, v5
    ds_write_b128 v224, v[16:19] offset:0
    ds_write_b128 v224, v[20:23] offset:1024
    ds_write_b128 v224, v[32:35] offset:2048
    ds_write_b128 v224, v[36:39] offset:3072
    ds_write_b128 v224, v[48:51] offset:4096
    ds_write_b128 v224, v[52:55] offset:5120
t2_w0:
    s_cmp_eq_u32 s32, 1
    s_cbranch_scc1 t2_w1
    s_sub_u32 s91, 4, s32
    s_and_b32 s91, s91, 3
    s_mul_i32 s91, s91, 6144
    s_add_u32 s91, s91, s67
    v_add_u32 v224, s91, v5
    ds_write_b128 v224, v[64:67] offset:0
    ds_write_b128 v224, v[68:71] offset:1024
    ds_write_b128 v224, v[80:83] offset:2048
    ds_write_b128 v224, v[84:87] offset:3072
    ds_write_b128 v224, v[96:99] offset:4096
    ds_write_b128 v224, v[100:103] offset:5120
t2_w1:
    s_cmp_eq_u32 s32, 2
    s_cbranch_scc1 t2_w2
    s_sub_u32 s91, 5, s32
    s_and_b32 s91, s91, 3
    s_mul_i32 s91, s91, 6144
    s_add_u32 s91, s91, s67
    v_add_u32 v224, s91, v5
    ds_write_b128 v224, v[24:27] offset:0
    ds_write_b128 v224, v[28:31] offset:1024
    ds_write_b128 v224, v[40:43] offset:2048
    ds_write_b128 v224, v[44:47] offset:3072
    ds_write_b128 v224, v[56:59] offset:4096
    ds_write_b128 v224, v[60:63] offset:5120
t2_w2:
    s_cmp_eq_u32 s32, 3
    s_cbranch_scc1 t2_w3
    s_sub_u32 s91, 6, s32
    s_and_b32 s91, s91, 3
    s_mul_i32 s91, s91, 6144
    s_add_u32 s91, s91, s67
    v_add_u32 v224, s91, v5
    ds_write_b128 v224, v[72:75] offset:0
    ds_write_b128 v224, v[76:79] offset:1024
    ds_write_b128 v224, v[88:91] offset:2048
    ds_write_b128 v224, v[92:95] offset:3072
    ds_write_b128 v224, v[104:107] offset:4096
    ds_write_b128 v224, v[108:111] offset:5120
t2_w3:
    s_add_u32 s91, s32, 1
    s_and_b32 s91, s91, 3
    s_mul_i32 s91, s91, 18432
    s_add_u32 s91, s91, 12288
    v_add_u32 v225, s91, v5
    s_add_u32 s91, s32, 2
    s_and_b32 s91, s91, 3
    s_mul_i32 s91, s91, 18432
    s_add_u32 s91, s91, 6144
    v_add_u32 v226, s91, v5
    s_add_u32 s91, s32, 3
    s_and_b32 s91, s91, 3
    s_mul_i32 s91, s91, 18432
    s_add_u32 s91, s91, 0
    v_add_u32 v227, s91, v5
    s_cmp_lg_u32 s32, 0
    s_cbranch_scc1 t2_o0
    v_mov_b32 v184, v16
    v_mov_b32 v185, v17
    v_mov_b32 v186, v18
    v_mov_b32 v187, v19
    v_mov_b32 v188, v20
    v_mov_b32 v189, v21
    v_mov_b32 v190, v22
    v_mov_b32 v191, v23
    v_mov_b32 v192, v32
    v_mov_b32 v193, v33
    v_mov_b32 v194, v34
    v_mov_b32 v195, v35
    v_mov_b32 v196, v36
    v_mov_b32 v197, v37
    v_mov_b32 v198, v38
    v_mov_b32 v199, v39
    v_mov_b32 v200, v48
    v_mov_b32 v201, v49
    v_mov_b32 v202, v50
    v_mov_b32 v203, v51
    v_mov_b32 v204, v52
    v_mov_b32 v205, v53
    v_mov_b32 v206, v54
    v_mov_b32 v207, v55
t2_o0:
    s_cmp_lg_u32 s32, 1
    s_cbranch_scc1 t2_o1
    v_mov_b32 v184, v64
    v_mov_b32 v185, v65
    v_mov_b32 v186, v66
    v_mov_b32 v187, v67
    v_mov_b32 v188, v68
    v_mov_b32 v189, v69
    v_mov_b32 v190, v70
    v_mov_b32 v191, v71
    v_mov_b32 v192, v80
    v_mov_b32 v193, v81
    v_mov_b32 v194, v82
    v_mov_b32 v195, v83
    v_mov_b32 v196, v84
    v_mov_b32 v197, v85
    v_mov_b32 v198, v86
    v_mov_b32 v199, v87
    v_mov_b32 v200, v96
    v_mov_b32 v201, v97
    v_mov_b32 v202, v98
    v_mov_b32 v203, v99
    v_mov_b32 v204, v100
    v_mov_b32 v205, v101
    v_mov_b32 v206, v102
    v_mov_b32 v207, v103
t2_o1:
    s_cmp_lg_u32 s32, 2
    s_cbranch_scc1 t2_o2
    v_mov_b32 v184, v24
    v_mov_b32 v185, v25
    v_mov_b32 v186, v26
    v_mov_b32 v187, v27
    v_mov_b32 v188, v28
    v_mov_b32 v189, v29
    v_mov_b32 v190, v30
    v_mov_b32 v191, v31
    v_mov_b32 v192, v40
    v_mov_b32 v193, v41
    v_mov_b32 v194, v42
    v_mov_b32 v195, v43
    v_mov_b32 v196, v44
    v_mov_b32 v197, v45
    v_mov_b32 v198, v46
    v_mov_b32 v199, v47
    v_mov_b32 v200, v56
    v_mov_b32 v201, v57
    v_mov_b32 v202, v58
    v_mov_b32 v203, v59
    v_mov_b32 v204, v60
    v_mov_b32 v205, v61
    v_mov_b32 v206, v62
    v_mov_b32 v207, v63
t2_o2:
    s_cmp_lg_u32 s32, 3
    s_cbranch_scc1 t2_o3
    v_mov_b32 v184, v72
    v_mov_b32 v185, v73
    v_mov_b32 v186, v74
    v_mov_b32 v187, v75
    v_mov_b32 v188, v76
    v_mov_b32 v189, v77
    v_mov_b32 v190, v78
    v_mov_b32 v191, v79
    v_mov_b32 v192, v88
    v_mov_b32 v193, v89
    v_mov_b32 v194, v90
    v_mov_b32 v195, v91
    v_mov_b32 v196, v92
    v_mov_b32 v197, v93
    v_mov_b32 v198, v94
    v_mov_b32 v199, v95
    v_mov_b32 v200, v104
    v_mov_b32 v201, v105
    v_mov_b32 v202, v106
    v_mov_b32 v203, v107
    v_mov_b32 v204, v108
    v_mov_b32 v205, v109
    v_mov_b32 v206, v110
    v_mov_b32 v207, v111
t2_o3:
    s_waitcnt lgkmcnt(0)
    s_barrier
    ds_read_b128 v[16:19], v225 offset:0
    ds_read_b128 v[20:23], v225 offset:1024
    ds_read_b128 v[24:27], v225 offset:2048
    ds_read_b128 v[28:31], v225 offset:3072
    ds_read_b128 v[32:35], v225 offset:4096
    ds_read_b128 v[36:39], v225 offset:5120
    ds_read_b128 v[40:43], v226 offset:0
    ds_read_b128 v[44:47], v226 offset:1024
    ds_read_b128 v[48:51], v226 offset:2048
    ds_read_b128 v[52:55], v226 offset:3072
    ds_read_b128 v[56:59], v226 offset:4096
    ds_read_b128 v[60:63], v226 offset:5120
    ds_read_b128 v[64:67], v227 offset:0
    ds_read_b128 v[68:71], v227 offset:1024
    ds_read_b128 v[72:75], v227 offset:2048
    ds_read_b128 v[76:79], v227 offset:3072
    ds_read_b128 v[80:83], v227 offset:4096
    ds_read_b128 v[84:87], v227 offset:5120
    s_waitcnt lgkmcnt(12)
    v_pk_add_f32 v[184:185], v[184:185], v[16:17]
    v_pk_add_f32 v[186:187], v[186:187], v[18:19]
    v_pk_add_f32 v[188:189], v[188:189], v[20:21]
    v_pk_add_f32 v[190:191], v[190:191], v[22:23]
    v_pk_add_f32 v[192:193], v[192:193], v[24:25]
    v_pk_add_f32 v[194:195], v[194:195], v[26:27]
    v_pk_add_f32 v[196:197], v[196:197], v[28:29]
    v_pk_add_f32 v[198:199], v[198:199], v[30:31]
    v_pk_add_f32 v[200:201], v[200:201], v[32:33]
    v_pk_add_f32 v[202:203], v[202:203], v[34:35]
    v_pk_add_f32 v[204:205], v[204:205], v[36:37]
    v_pk_add_f32 v[206:207], v[206:207], v[38:39]
    s_waitcnt lgkmcnt(6)
    v_pk_add_f32 v[184:185], v[184:185], v[40:41]
    v_pk_add_f32 v[186:187], v[186:187], v[42:43]
    v_pk_add_f32 v[188:189], v[188:189], v[44:45]
    v_pk_add_f32 v[190:191], v[190:191], v[46:47]
    v_pk_add_f32 v[192:193], v[192:193], v[48:49]
    v_pk_add_f32 v[194:195], v[194:195], v[50:51]
    v_pk_add_f32 v[196:197], v[196:197], v[52:53]
    v_pk_add_f32 v[198:199], v[198:199], v[54:55]
    v_pk_add_f32 v[200:201], v[200:201], v[56:57]
    v_pk_add_f32 v[202:203], v[202:203], v[58:59]
    v_pk_add_f32 v[204:205], v[204:205], v[60:61]
    v_pk_add_f32 v[206:207], v[206:207], v[62:63]
    s_waitcnt lgkmcnt(0)
    v_pk_add_f32 v[184:185], v[184:185], v[64:65]
    v_pk_add_f32 v[186:187], v[186:187], v[66:67]
    v_pk_add_f32 v[188:189], v[188:189], v[68:69]
    v_pk_add_f32 v[190:191], v[190:191], v[70:71]
    v_pk_add_f32 v[192:193], v[192:193], v[72:73]
    v_pk_add_f32 v[194:195], v[194:195], v[74:75]
    v_pk_add_f32 v[196:197], v[196:197], v[76:77]
    v_pk_add_f32 v[198:199], v[198:199], v[78:79]
    v_pk_add_f32 v[200:201], v[200:201], v[80:81]
    v_pk_add_f32 v[202:203], v[202:203], v[82:83]
    v_pk_add_f32 v[204:205], v[204:205], v[84:85]
    v_pk_add_f32 v[206:207], v[206:207], v[86:87]
    s_mov_b32 s49, 0xffff0000
    s_waitcnt vmcnt(0)
    v_lshlrev_b32 v224, 16, v212
    v_and_b32 v225, s49, v212
    v_pk_add_f32 v[184:185], v[184:185], v[224:225]
    v_lshlrev_b32 v224, 16, v213
    v_and_b32 v225, s49, v213
    v_pk_add_f32 v[186:187], v[186:187], v[224:225]
    v_lshlrev_b32 v224, 16, v214
    v_and_b32 v225, s49, v214
    v_pk_add_f32 v[188:189], v[188:189], v[224:225]
    v_lshlrev_b32 v224, 16, v215
    v_and_b32 v225, s49, v215
    v_pk_add_f32 v[190:191], v[190:191], v[224:225]
    v_lshlrev_b32 v224, 16, v216
    v_and_b32 v225, s49, v216
    v_pk_add_f32 v[192:193], v[192:193], v[224:225]
    v_lshlrev_b32 v224, 16, v217
    v_and_b32 v225, s49, v217
    v_pk_add_f32 v[194:195], v[194:195], v[224:225]
    v_lshlrev_b32 v224, 16, v218
    v_and_b32 v225, s49, v218
    v_pk_add_f32 v[196:197], v[196:197], v[224:225]
    v_lshlrev_b32 v224, 16, v219
    v_and_b32 v225, s49, v219
    v_pk_add_f32 v[198:199], v[198:199], v[224:225]
    v_lshlrev_b32 v224, 16, v220
    v_and_b32 v225, s49, v220
    v_pk_add_f32 v[200:201], v[200:201], v[224:225]
    v_lshlrev_b32 v224, 16, v221
    v_and_b32 v225, s49, v221
    v_pk_add_f32 v[202:203], v[202:203], v[224:225]
    v_lshlrev_b32 v224, 16, v222
    v_and_b32 v225, s49, v222
    v_pk_add_f32 v[204:205], v[204:205], v[224:225]
    v_lshlrev_b32 v224, 16, v223
    v_and_b32 v225, s49, v223
    v_pk_add_f32 v[206:207], v[206:207], v[224:225]
    s_cmp_lg_u32 s46, 0
    s_cbranch_scc1 t2_i0
    v_mov_b32 v16, v184
    v_mov_b32 v24, 0
    v_mov_b32 v17, v185
    v_mov_b32 v25, 0
    v_mov_b32 v18, v186
    v_mov_b32 v26, 0
    v_mov_b32 v19, v187
    v_mov_b32 v27, 0
    v_mov_b32 v20, v188
    v_mov_b32 v28, 0
    v_mov_b32 v21, v189
    v_mov_b32 v29, 0
    v_mov_b32 v22, v190
    v_mov_b32 v30, 0
    v_mov_b32 v23, v191
    v_mov_b32 v31, 0
    v_mov_b32 v32, v192
    v_mov_b32 v40, 0
    v_mov_b32 v33, v193
    v_mov_b32 v41, 0
    v_mov_b32 v34, v194
    v_mov_b32 v42, 0
    v_mov_b32 v35, v195
    v_mov_b32 v43, 0
    v_mov_b32 v36, v196
    v_mov_b32 v44, 0
    v_mov_b32 v37, v197
    v_mov_b32 v45, 0
    v_mov_b32 v38, v198
    v_mov_b32 v46, 0
    v_mov_b32 v39, v199
    v_mov_b32 v47, 0
    v_mov_b32 v48, v200
    v_mov_b32 v56, 0
    v_mov_b32 v49, v201
    v_mov_b32 v57, 0
    v_mov_b32 v50, v202
    v_mov_b32 v58, 0
    v_mov_b32 v51, v203
    v_mov_b32 v59, 0
    v_mov_b32 v52, v204
    v_mov_b32 v60, 0
    v_mov_b32 v53, v205
    v_mov_b32 v61, 0
    v_mov_b32 v54, v206
    v_mov_b32 v62, 0
    v_mov_b32 v55, v207
    v_mov_b32 v63, 0
t2_i0:
    s_cmp_lg_u32 s46, 1
    s_cbranch_scc1 t2_i1
    v_mov_b32 v24, v184
    v_mov_b32 v16, 0
    v_mov_b32 v25, v185
    v_mov_b32 v17, 0
    v_mov_b32 v26, v186
    v_mov_b32 v18, 0
    v_mov_b32 v27, v187
    v_mov_b32 v19, 0
    v_mov_b32 v28, v188
    v_mov_b32 v20, 0
    v_mov_b32 v29, v189
    v_mov_b32 v21, 0
    v_mov_b32 v30, v190
    v_mov_b32 v22, 0
    v_mov_b32 v31, v191
    v_mov_b32 v23, 0
    v_mov_b32 v40, v192
    v_mov_b32 v32, 0
    v_mov_b32 v41, v193
    v_mov_b32 v33, 0
    v_mov_b32 v42, v194
    v_mov_b32 v34, 0
    v_mov_b32 v43, v195
    v_mov_b32 v35, 0
    v_mov_b32 v44, v196
    v_mov_b32 v36, 0
    v_mov_b32 v45, v197
    v_mov_b32 v37, 0
    v_mov_b32 v46, v198
    v_mov_b32 v38, 0
    v_mov_b32 v47, v199
    v_mov_b32 v39, 0
    v_mov_b32 v56, v200
    v_mov_b32 v48, 0
    v_mov_b32 v57, v201
    v_mov_b32 v49, 0
    v_mov_b32 v58, v202
    v_mov_b32 v50, 0
    v_mov_b32 v59, v203
    v_mov_b32 v51, 0
    v_mov_b32 v60, v204
    v_mov_b32 v52, 0
    v_mov_b32 v61, v205
    v_mov_b32 v53, 0
    v_mov_b32 v62, v206
    v_mov_b32 v54, 0
    v_mov_b32 v63, v207
    v_mov_b32 v55, 0
t2_i1:
    s_setprio 0
    s_barrier
    s_mul_i32 s47, s46, 409600
    s_mul_i32 s48, s45, 20480
    s_add_u32 s47, s47, s48
    s_mul_i32 s48, s64, 192
    s_add_u32 s47, s47, s48
    s_mul_i32 s48, s46, 36864
    s_mul_i32 s50, s45, 3072
    s_add_u32 s50, s50, s48
    s_add_u32 m0, s50, 0
    s_add_u32 s91, s47, 0
    buffer_load_dwordx4 v8, s[80:83], s91 offen lds
    s_add_u32 m0, s50, 1024
    s_add_u32 s91, s47, 64
    buffer_load_dwordx4 v8, s[80:83], s91 offen lds
    s_add_u32 m0, s50, 2048
    s_add_u32 s91, s47, 128
    buffer_load_dwordx4 v8, s[80:83], s91 offen lds
    s_add_u32 m0, s50, 6144
    s_add_u32 s91, s47, 40960
    buffer_load_dwordx4 v8, s[80:83], s91 offen lds
    s_add_u32 m0, s50, 7168
    s_add_u32 s91, s47, 41024
    buffer_load_dwordx4 v8, s[80:83], s91 offen lds
    s_add_u32 m0, s50, 8192
    s_add_u32 s91, s47, 41088
    buffer_load_dwordx4 v8, s[80:83], s91 offen lds
    s_add_u32 m0, s50, 12288
    s_add_u32 s91, s47, 81920
    buffer_load_dwordx4 v8, s[80:83], s91 offen lds
    s_add_u32 m0, s50, 13312
    s_add_u32 s91, s47, 81984
    buffer_load_dwordx4 v8, s[80:83], s91 offen lds
    s_add_u32 m0, s50, 14336
    s_add_u32 s91, s47, 82048
    buffer_load_dwordx4 v8, s[80:83], s91 offen lds
    s_add_u32 m0, s50, 18432
    s_add_u32 s91, s47, 122880
    buffer_load_dwordx4 v8, s[80:83], s91 offen lds
    s_add_u32 m0, s50, 19456
    s_add_u32 s91, s47, 122944
    buffer_load_dwordx4 v8, s[80:83], s91 offen lds
    s_add_u32 m0, s50, 20480
    s_add_u32 s91, s47, 123008
    buffer_load_dwordx4 v8, s[80:83], s91 offen lds
    s_add_u32 m0, s50, 24576
    s_add_u32 s91, s47, 163840
    buffer_load_dwordx4 v8, s[80:83], s91 offen lds
    s_add_u32 m0, s50, 25600
    s_add_u32 s91, s47, 163904
    buffer_load_dwordx4 v8, s[80:83], s91 offen lds
    s_add_u32 m0, s50, 26624
    s_add_u32 s91, s47, 163968
    buffer_load_dwordx4 v8, s[80:83], s91 offen lds
    s_add_u32 m0, s50, 30720
    s_add_u32 s91, s47, 204800
    buffer_load_dwordx4 v8, s[80:83], s91 offen lds
    s_add_u32 m0, s50, 31744
    s_add_u32 s91, s47, 204864
    buffer_load_dwordx4 v8, s[80:83], s91 offen lds
    s_add_u32 m0, s50, 32768
    s_add_u32 s91, s47, 204928
    buffer_load_dwordx4 v8, s[80:83], s91 offen lds
    s_sub_u32 s91, s48, s67
    v_add_u32 v9, s91, v9
    s_lshl_b32 s89, s63, 1
    s_add_u32 s89, s89, s45
    s_mul_i32 s89, s89, 40
    s_mul_i32 s91, s46, 20
    s_add_u32 s89, s89, s91
    s_lshl_b32 s89, s89, 10
    s_add_u32 s89, s89, 5439488
    s_lshl_b32 s93, s63, 8
    s_add_u32 s93, s93, 5427200
    s_waitcnt vmcnt(0)
    s_cmp_lg_u32 s32, 0
    s_cbranch_scc1 main_polled2
    v_mov_b32 v224, 0
    s_mov_b64 exec, 1
main_poll2:
    buffer_load_dword v226, v224, s[28:31], s93 offen sc1
    s_waitcnt vmcnt(0)
    v_readfirstlane_b32 s95, v226
    s_nop 0
    s_cmp_ge_u32 s95, 8
    s_cbranch_scc1 main_pdone2
    s_sleep 4
    s_branch main_poll2
main_pdone2:
    s_mov_b64 exec, -1
main_polled2:
    s_barrier
    buffer_load_dwordx4 v[64:67], v5, s[28:31], s89 offen offset:0 sc1
    buffer_load_dwordx4 v[68:71], v5, s[28:31], s89 offen offset:1024 sc1
    buffer_load_dwordx4 v[72:75], v5, s[28:31], s89 offen offset:2048 sc1
    buffer_load_dwordx4 v[76:79], v5, s[28:31], s89 offen offset:3072 sc1
    s_add_u32 s89, s89, 4096
    buffer_load_dwordx4 v[80:83], v5, s[28:31], s89 offen offset:0 sc1
    buffer_load_dwordx4 v[84:87], v5, s[28:31], s89 offen offset:1024 sc1
    buffer_load_dwordx4 v[88:91], v5, s[28:31], s89 offen offset:2048 sc1
    buffer_load_dwordx4 v[92:95], v5, s[28:31], s89 offen offset:3072 sc1
    s_add_u32 s89, s89, 4096
    buffer_load_dwordx4 v[96:99], v5, s[28:31], s89 offen offset:0 sc1
    buffer_load_dwordx4 v[100:103], v5, s[28:31], s89 offen offset:1024 sc1
    buffer_load_dwordx4 v[104:107], v5, s[28:31], s89 offen offset:2048 sc1
    buffer_load_dwordx4 v[108:111], v5, s[28:31], s89 offen offset:3072 sc1
    s_add_u32 s89, s89, 4096
    buffer_load_dwordx4 v[136:139], v5, s[28:31], s89 offen offset:0 sc1
    buffer_load_dwordx4 v[140:143], v5, s[28:31], s89 offen offset:1024 sc1
    buffer_load_dwordx4 v[144:147], v5, s[28:31], s89 offen offset:2048 sc1
    buffer_load_dwordx4 v[148:151], v5, s[28:31], s89 offen offset:3072 sc1
    s_add_u32 s89, s89, 4096
    buffer_load_dwordx4 v[152:155], v5, s[28:31], s89 offen offset:0 sc1
    buffer_load_dwordx4 v[156:159], v5, s[28:31], s89 offen offset:1024 sc1
    buffer_load_dwordx4 v[160:163], v5, s[28:31], s89 offen offset:2048 sc1
    buffer_load_dwordx4 v[164:167], v5, s[28:31], s89 offen offset:3072 sc1
    ds_read_b64_tr_b16 v[112:113], v9 offset:0
    ds_read_b64_tr_b16 v[114:115], v9 offset:512
    ds_read_b64_tr_b16 v[116:117], v9 offset:1024
    ds_read_b64_tr_b16 v[118:119], v9 offset:1536
    ds_read_b64_tr_b16 v[120:121], v9 offset:2048
    ds_read_b64_tr_b16 v[122:123], v9 offset:2560
    ds_read_b64_tr_b16 v[124:125], v9 offset:3072
    ds_read_b64_tr_b16 v[126:127], v9 offset:3584
    ds_read_b64_tr_b16 v[128:129], v9 offset:4096
    ds_read_b64_tr_b16 v[130:131], v9 offset:4608
    ds_read_b64_tr_b16 v[132:133], v9 offset:5120
    ds_read_b64_tr_b16 v[134:135], v9 offset:5632
    s_waitcnt vmcnt(19) lgkmcnt(6)
    v_mfma_f32_32x32x16_bf16 v[16:31], v[112:115], v[64:67], v[16:31]
    v_mfma_f32_32x32x16_bf16 v[32:47], v[116:119], v[64:67], v[32:47]
    v_mfma_f32_32x32x16_bf16 v[48:63], v[120:123], v[64:67], v[48:63]
    ds_read_b64_tr_b16 v[112:113], v9 offset:6144
    ds_read_b64_tr_b16 v[114:115], v9 offset:6656
    ds_read_b64_tr_b16 v[116:117], v9 offset:7168
    ds_read_b64_tr_b16 v[118:119], v9 offset:7680
    ds_read_b64_tr_b16 v[120:121], v9 offset:8192
    ds_read_b64_tr_b16 v[122:123], v9 offset:8704
    s_waitcnt vmcnt(18) lgkmcnt(6)
    v_mfma_f32_32x32x16_bf16 v[16:31], v[124:127], v[68:71], v[16:31]
    v_mfma_f32_32x32x16_bf16 v[32:47], v[128:131], v[68:71], v[32:47]
    v_mfma_f32_32x32x16_bf16 v[48:63], v[132:135], v[68:71], v[48:63]
    ds_read_b64_tr_b16 v[124:125], v9 offset:9216
    ds_read_b64_tr_b16 v[126:127], v9 offset:9728
    ds_read_b64_tr_b16 v[128:129], v9 offset:10240
    ds_read_b64_tr_b16 v[130:131], v9 offset:10752
    ds_read_b64_tr_b16 v[132:133], v9 offset:11264
    ds_read_b64_tr_b16 v[134:135], v9 offset:11776
    s_waitcnt vmcnt(17) lgkmcnt(6)
    v_mfma_f32_32x32x16_bf16 v[16:31], v[112:115], v[72:75], v[16:31]
    v_mfma_f32_32x32x16_bf16 v[32:47], v[116:119], v[72:75], v[32:47]
    v_mfma_f32_32x32x16_bf16 v[48:63], v[120:123], v[72:75], v[48:63]
    ds_read_b64_tr_b16 v[112:113], v9 offset:12288
    ds_read_b64_tr_b16 v[114:115], v9 offset:12800
    ds_read_b64_tr_b16 v[116:117], v9 offset:13312
    ds_read_b64_tr_b16 v[118:119], v9 offset:13824
    ds_read_b64_tr_b16 v[120:121], v9 offset:14336
    ds_read_b64_tr_b16 v[122:123], v9 offset:14848
    s_waitcnt vmcnt(16) lgkmcnt(6)
    v_mfma_f32_32x32x16_bf16 v[16:31], v[124:127], v[76:79], v[16:31]
    v_mfma_f32_32x32x16_bf16 v[32:47], v[128:131], v[76:79], v[32:47]
    v_mfma_f32_32x32x16_bf16 v[48:63], v[132:135], v[76:79], v[48:63]
    s_barrier
    s_add_u32 m0, s50, 0
    s_add_u32 s91, s47, 245760
    buffer_load_dwordx4 v8, s[80:83], s91 offen lds
    s_add_u32 m0, s50, 1024
    s_add_u32 s91, s47, 245824
    buffer_load_dwordx4 v8, s[80:83], s91 offen lds
    s_add_u32 m0, s50, 2048
    s_add_u32 s91, s47, 245888
    buffer_load_dwordx4 v8, s[80:83], s91 offen lds
    s_add_u32 m0, s50, 6144
    s_add_u32 s91, s47, 286720
    buffer_load_dwordx4 v8, s[80:83], s91 offen lds
    s_add_u32 m0, s50, 7168
    s_add_u32 s91, s47, 286784
    buffer_load_dwordx4 v8, s[80:83], s91 offen lds
    s_add_u32 m0, s50, 8192
    s_add_u32 s91, s47, 286848
    buffer_load_dwordx4 v8, s[80:83], s91 offen lds
    ds_read_b64_tr_b16 v[124:125], v9 offset:15360
    ds_read_b64_tr_b16 v[126:127], v9 offset:15872
    ds_read_b64_tr_b16 v[128:129], v9 offset:16384
    ds_read_b64_tr_b16 v[130:131], v9 offset:16896
    ds_read_b64_tr_b16 v[132:133], v9 offset:17408
    ds_read_b64_tr_b16 v[134:135], v9 offset:17920
    s_waitcnt vmcnt(21) lgkmcnt(6)
    v_mfma_f32_32x32x16_bf16 v[16:31], v[112:115], v[80:83], v[16:31]
    v_mfma_f32_32x32x16_bf16 v[32:47], v[116:119], v[80:83], v[32:47]
    v_mfma_f32_32x32x16_bf16 v[48:63], v[120:123], v[80:83], v[48:63]
    ds_read_b64_tr_b16 v[112:113], v9 offset:18432
    ds_read_b64_tr_b16 v[114:115], v9 offset:18944
    ds_read_b64_tr_b16 v[116:117], v9 offset:19456
    ds_read_b64_tr_b16 v[118:119], v9 offset:19968
    ds_read_b64_tr_b16 v[120:121], v9 offset:20480
    ds_read_b64_tr_b16 v[122:123], v9 offset:20992
    s_waitcnt vmcnt(20) lgkmcnt(6)
    v_mfma_f32_32x32x16_bf16 v[16:31], v[124:127], v[84:87], v[16:31]
    v_mfma_f32_32x32x16_bf16 v[32:47], v[128:131], v[84:87], v[32:47]
    v_mfma_f32_32x32x16_bf16 v[48:63], v[132:135], v[84:87], v[48:63]
    ds_read_b64_tr_b16 v[124:125], v9 offset:21504
    ds_read_b64_tr_b16 v[126:127], v9 offset:22016
    ds_read_b64_tr_b16 v[128:129], v9 offset:22528
    ds_read_b64_tr_b16 v[130:131], v9 offset:23040
    ds_read_b64_tr_b16 v[132:133], v9 offset:23552
    ds_read_b64_tr_b16 v[134:135], v9 offset:24064
    s_waitcnt vmcnt(19) lgkmcnt(6)
    v_mfma_f32_32x32x16_bf16 v[16:31], v[112:115], v[88:91], v[16:31]
    v_mfma_f32_32x32x16_bf16 v[32:47], v[116:119], v[88:91], v[32:47]
    v_mfma_f32_32x32x16_bf16 v[48:63], v[120:123], v[88:91], v[48:63]
    ds_read_b64_tr_b16 v[112:113], v9 offset:24576
    ds_read_b64_tr_b16 v[114:115], v9 offset:25088
    ds_read_b64_tr_b16 v[116:117], v9 offset:25600
    ds_read_b64_tr_b16 v[118:119], v9 offset:26112
    ds_read_b64_tr_b16 v[120:121], v9 offset:26624
    ds_read_b64_tr_b16 v[122:123], v9 offset:27136
    s_waitcnt vmcnt(18) lgkmcnt(6)
    v_mfma_f32_32x32x16_bf16 v[16:31], v[124:127], v[92:95], v[16:31]
    v_mfma_f32_32x32x16_bf16 v[32:47], v[128:131], v[92:95], v[32:47]
    v_mfma_f32_32x32x16_bf16 v[48:63], v[132:135], v[92:95], v[48:63]
    s_barrier
    s_add_u32 m0, s50, 12288
    s_add_u32 s91, s47, 327680
    buffer_load_dwordx4 v8, s[80:83], s91 offen lds
    s_add_u32 m0, s50, 13312
    s_add_u32 s91, s47, 327744
    buffer_load_dwordx4 v8, s[80:83], s91 offen lds
    s_add_u32 m0, s50, 14336
    s_add_u32 s91, s47, 327808
    buffer_load_dwordx4 v8, s[80:83], s91 offen lds
    s_add_u32 m0, s50, 18432
    s_add_u32 s91, s47, 368640
    buffer_load_dwordx4 v8, s[80:83], s91 offen lds
    s_add_u32 m0, s50, 19456
    s_add_u32 s91, s47, 368704
    buffer_load_dwordx4 v8, s[80:83], s91 offen lds
    s_add_u32 m0, s50, 20480
    s_add_u32 s91, s47, 368768
    buffer_load_dwordx4 v8, s[80:83], s91 offen lds
    ds_read_b64_tr_b16 v[124:125], v9 offset:27648
    ds_read_b64_tr_b16 v[126:127], v9 offset:28160
    ds_read_b64_tr_b16 v[128:129], v9 offset:28672
    ds_read_b64_tr_b16 v[130:131], v9 offset:29184
    ds_read_b64_tr_b16 v[132:133], v9 offset:29696
    ds_read_b64_tr_b16 v[134:135], v9 offset:30208
    s_waitcnt vmcnt(23) lgkmcnt(6)
    v_mfma_f32_32x32x16_bf16 v[16:31], v[112:115], v[96:99], v[16:31]
    v_mfma_f32_32x32x16_bf16 v[32:47], v[116:119], v[96:99], v[32:47]
    v_mfma_f32_32x32x16_bf16 v[48:63], v[120:123], v[96:99], v[48:63]
    ds_read_b64_tr_b16 v[112:113], v9 offset:30720
    ds_read_b64_tr_b16 v[114:115], v9 offset:31232
    ds_read_b64_tr_b16 v[116:117], v9 offset:31744
    ds_read_b64_tr_b16 v[118:119], v9 offset:32256
    ds_read_b64_tr_b16 v[120:121], v9 offset:32768
    ds_read_b64_tr_b16 v[122:123], v9 offset:33280
    s_waitcnt vmcnt(22) lgkmcnt(6)
    v_mfma_f32_32x32x16_bf16 v[16:31], v[124:127], v[100:103], v[16:31]
    v_mfma_f32_32x32x16_bf16 v[32:47], v[128:131], v[100:103], v[32:47]
    v_mfma_f32_32x32x16_bf16 v[48:63], v[132:135], v[100:103], v[48:63]
    ds_read_b64_tr_b16 v[124:125], v9 offset:33792
    ds_read_b64_tr_b16 v[126:127], v9 offset:34304
    ds_read_b64_tr_b16 v[128:129], v9 offset:34816
    ds_read_b64_tr_b16 v[130:131], v9 offset:35328
    ds_read_b64_tr_b16 v[132:133], v9 offset:35840
    ds_read_b64_tr_b16 v[134:135], v9 offset:36352
    s_waitcnt vmcnt(21) lgkmcnt(6)
    v_mfma_f32_32x32x16_bf16 v[16:31], v[112:115], v[104:107], v[16:31]
    v_mfma_f32_32x32x16_bf16 v[32:47], v[116:119], v[104:107], v[32:47]
    v_mfma_f32_32x32x16_bf16 v[48:63], v[120:123], v[104:107], v[48:63]
    s_waitcnt vmcnt(6)
    s_barrier
    ds_read_b64_tr_b16 v[112:113], v9 offset:0
    ds_read_b64_tr_b16 v[114:115], v9 offset:512
    ds_read_b64_tr_b16 v[116:117], v9 offset:1024
    ds_read_b64_tr_b16 v[118:119], v9 offset:1536
    ds_read_b64_tr_b16 v[120:121], v9 offset:2048
    ds_read_b64_tr_b16 v[122:123], v9 offset:2560
    s_waitcnt vmcnt(20) lgkmcnt(6)
    v_mfma_f32_32x32x16_bf16 v[16:31], v[124:127], v[108:111], v[16:31]
    v_mfma_f32_32x32x16_bf16 v[32:47], v[128:131], v[108:111], v[32:47]
    v_mfma_f32_32x32x16_bf16 v[48:63], v[132:135], v[108:111], v[48:63]
    ds_read_b64_tr_b16 v[124:125], v9 offset:3072
    ds_read_b64_tr_b16 v[126:127], v9 offset:3584
    ds_read_b64_tr_b16 v[128:129], v9 offset:4096
    ds_read_b64_tr_b16 v[130:131], v9 offset:4608
    ds_read_b64_tr_b16 v[132:133], v9 offset:5120
    ds_read_b64_tr_b16 v[134:135], v9 offset:5632
    s_waitcnt vmcnt(19) lgkmcnt(6)
    v_mfma_f32_32x32x16_bf16 v[16:31], v[112:115], v[136:139], v[16:31]
    v_mfma_f32_32x32x16_bf16 v[32:47], v[116:119], v[136:139], v[32:47]
    v_mfma_f32_32x32x16_bf16 v[48:63], v[120:123], v[136:139], v[48:63]
    ds_read_b64_tr_b16 v[112:113], v9 offset:6144
    ds_read_b64_tr_b16 v[114:115], v9 offset:6656
    ds_read_b64_tr_b16 v[116:117], v9 offset:7168
    ds_read_b64_tr_b16 v[118:119], v9 offset:7680
    ds_read_b64_tr_b16 v[120:121], v9 offset:8192
    ds_read_b64_tr_b16 v[122:123], v9 offset:8704
    s_waitcnt vmcnt(18) lgkmcnt(6)
    v_mfma_f32_32x32x16_bf16 v[16:31], v[124:127], v[140:143], v[16:31]
    v_mfma_f32_32x32x16_bf16 v[32:47], v[128:131], v[140:143], v[32:47]
    v_mfma_f32_32x32x16_bf16 v[48:63], v[132:135], v[140:143], v[48:63]
    ds_read_b64_tr_b16 v[124:125], v9 offset:9216
    ds_read_b64_tr_b16 v[126:127], v9 offset:9728
    ds_read_b64_tr_b16 v[128:129], v9 offset:10240
    ds_read_b64_tr_b16 v[130:131], v9 offset:10752
    ds_read_b64_tr_b16 v[132:133], v9 offset:11264
    ds_read_b64_tr_b16 v[134:135], v9 offset:11776
    s_waitcnt vmcnt(17) lgkmcnt(6)
    v_mfma_f32_32x32x16_bf16 v[16:31], v[112:115], v[144:147], v[16:31]
    v_mfma_f32_32x32x16_bf16 v[32:47], v[116:119], v[144:147], v[32:47]
    v_mfma_f32_32x32x16_bf16 v[48:63], v[120:123], v[144:147], v[48:63]
    s_waitcnt vmcnt(0)
    s_barrier
    ds_read_b64_tr_b16 v[112:113], v9 offset:12288
    ds_read_b64_tr_b16 v[114:115], v9 offset:12800
    ds_read_b64_tr_b16 v[116:117], v9 offset:13312
    ds_read_b64_tr_b16 v[118:119], v9 offset:13824
    ds_read_b64_tr_b16 v[120:121], v9 offset:14336
    ds_read_b64_tr_b16 v[122:123], v9 offset:14848
    s_waitcnt vmcnt(16) lgkmcnt(6)
    v_mfma_f32_32x32x16_bf16 v[16:31], v[124:127], v[148:151], v[16:31]
    v_mfma_f32_32x32x16_bf16 v[32:47], v[128:131], v[148:151], v[32:47]
    v_mfma_f32_32x32x16_bf16 v[48:63], v[132:135], v[148:151], v[48:63]
    ds_read_b64_tr_b16 v[124:125], v9 offset:15360
    ds_read_b64_tr_b16 v[126:127], v9 offset:15872
    ds_read_b64_tr_b16 v[128:129], v9 offset:16384
    ds_read_b64_tr_b16 v[130:131], v9 offset:16896
    ds_read_b64_tr_b16 v[132:133], v9 offset:17408
    ds_read_b64_tr_b16 v[134:135], v9 offset:17920
    s_waitcnt vmcnt(15) lgkmcnt(6)
    v_mfma_f32_32x32x16_bf16 v[16:31], v[112:115], v[152:155], v[16:31]
    v_mfma_f32_32x32x16_bf16 v[32:47], v[116:119], v[152:155], v[32:47]
    v_mfma_f32_32x32x16_bf16 v[48:63], v[120:123], v[152:155], v[48:63]
    ds_read_b64_tr_b16 v[112:113], v9 offset:18432
    ds_read_b64_tr_b16 v[114:115], v9 offset:18944
    ds_read_b64_tr_b16 v[116:117], v9 offset:19456
    ds_read_b64_tr_b16 v[118:119], v9 offset:19968
    ds_read_b64_tr_b16 v[120:121], v9 offset:20480
    ds_read_b64_tr_b16 v[122:123], v9 offset:20992
    s_waitcnt vmcnt(14) lgkmcnt(6)
    v_mfma_f32_32x32x16_bf16 v[16:31], v[124:127], v[156:159], v[16:31]
    v_mfma_f32_32x32x16_bf16 v[32:47], v[128:131], v[156:159], v[32:47]
    v_mfma_f32_32x32x16_bf16 v[48:63], v[132:135], v[156:159], v[48:63]
    ds_read_b64_tr_b16 v[124:125], v9 offset:21504
    ds_read_b64_tr_b16 v[126:127], v9 offset:22016
    ds_read_b64_tr_b16 v[128:129], v9 offset:22528
    ds_read_b64_tr_b16 v[130:131], v9 offset:23040
    ds_read_b64_tr_b16 v[132:133], v9 offset:23552
    ds_read_b64_tr_b16 v[134:135], v9 offset:24064
    s_waitcnt vmcnt(13) lgkmcnt(6)
    v_mfma_f32_32x32x16_bf16 v[16:31], v[112:115], v[160:163], v[16:31]
    v_mfma_f32_32x32x16_bf16 v[32:47], v[116:119], v[160:163], v[32:47]
    v_mfma_f32_32x32x16_bf16 v[48:63], v[120:123], v[160:163], v[48:63]
    s_waitcnt vmcnt(12) lgkmcnt(0)
    v_mfma_f32_32x32x16_bf16 v[16:31], v[124:127], v[164:167], v[16:31]
    v_mfma_f32_32x32x16_bf16 v[32:47], v[128:131], v[164:167], v[32:47]
    v_mfma_f32_32x32x16_bf16 v[48:63], v[132:135], v[164:167], v[48:63]
    s_setprio 2
    s_barrier
    v_add_u32 v224, s67, v5
    s_xor_b32 s91, s32, 2
    s_mul_i32 s91, s91, 18432
    v_add_u32 v225, s91, v5
    s_cmp_lg_u32 s46, 0
    s_cbranch_scc1 t2_x0
    s_nop 1
    ds_write_b128 v224, v[24:27] offset:0
    ds_write_b128 v224, v[28:31] offset:1024
    ds_write_b128 v224, v[40:43] offset:2048
    ds_write_b128 v224, v[44:47] offset:3072
    ds_write_b128 v224, v[56:59] offset:4096
    ds_write_b128 v224, v[60:63] offset:5120
    v_mov_b32 v184, v16
    v_mov_b32 v185, v17
    v_mov_b32 v186, v18
    v_mov_b32 v187, v19
    v_mov_b32 v188, v20
    v_mov_b32 v189, v21
    v_mov_b32 v190, v22
    v_mov_b32 v191, v23
    v_mov_b32 v192, v32
    v_mov_b32 v193, v33
    v_mov_b32 v194, v34
    v_mov_b32 v195, v35
    v_mov_b32 v196, v36
    v_mov_b32 v197, v37
    v_mov_b32 v198, v38
    v_mov_b32 v199, v39
    v_mov_b32 v200, v48
    v_mov_b32 v201, v49
    v_mov_b32 v202, v50
    v_mov_b32 v203, v51
    v_mov_b32 v204, v52
    v_mov_b32 v205, v53
    v_mov_b32 v206, v54
    v_mov_b32 v207, v55
t2_x0:
    s_cmp_lg_u32 s46, 1
    s_cbranch_scc1 t2_x1
    ds_write_b128 v224, v[16:19] offset:0
    ds_write_b128 v224, v[20:23] offset:1024
    ds_write_b128 v224, v[32:35] offset:2048
    ds_write_b128 v224, v[36:39] offset:3072
    ds_write_b128 v224, v[48:51] offset:4096
    ds_write_b128 v224, v[52:55] offset:5120
    v_mov_b32 v184, v24
    v_mov_b32 v185, v25
    v_mov_b32 v186, v26
    v_mov_b32 v187, v27
    v_mov_b32 v188, v28
    v_mov_b32 v189, v29
    v_mov_b32 v190, v30
    v_mov_b32 v191, v31
    v_mov_b32 v192, v40
    v_mov_b32 v193, v41
    v_mov_b32 v194, v42
    v_mov_b32 v195, v43
    v_mov_b32 v196, v44
    v_mov_b32 v197, v45
    v_mov_b32 v198, v46
    v_mov_b32 v199, v47
    v_mov_b32 v200, v56
    v_mov_b32 v201, v57
    v_mov_b32 v202, v58
    v_mov_b32 v203, v59
    v_mov_b32 v204, v60
    v_mov_b32 v205, v61
    v_mov_b32 v206, v62
    v_mov_b32 v207, v63
t2_x1:
    s_waitcnt lgkmcnt(0)
    s_barrier
    ds_read_b128 v[16:19], v225 offset:0
    ds_read_b128 v[20:23], v225 offset:1024
    ds_read_b128 v[24:27], v225 offset:2048
    ds_read_b128 v[28:31], v225 offset:3072
    ds_read_b128 v[32:35], v225 offset:4096
    ds_read_b128 v[36:39], v225 offset:5120
    s_waitcnt lgkmcnt(0)
    v_pk_add_f32 v[184:185], v[184:185], v[16:17]
    v_pk_add_f32 v[186:187], v[186:187], v[18:19]
    v_pk_add_f32 v[188:189], v[188:189], v[20:21]
    v_pk_add_f32 v[190:191], v[190:191], v[22:23]
    v_pk_add_f32 v[192:193], v[192:193], v[24:25]
    v_pk_add_f32 v[194:195], v[194:195], v[26:27]
    v_pk_add_f32 v[196:197], v[196:197], v[28:29]
    v_pk_add_f32 v[198:199], v[198:199], v[30:31]
    v_pk_add_f32 v[200:201], v[200:201], v[32:33]
    v_pk_add_f32 v[202:203], v[202:203], v[34:35]
    v_pk_add_f32 v[204:205], v[204:205], v[36:37]
    v_pk_add_f32 v[206:207], v[206:207], v[38:39]
    v_lshl_add_u32 v224, v3, 3, v10
    v_cvt_pk_bf16_f32 v184, v184, v185
    v_cvt_pk_bf16_f32 v185, v186, v187
    v_cvt_pk_bf16_f32 v186, v188, v189
    v_cvt_pk_bf16_f32 v187, v190, v191
    s_nop 0
    v_permlane32_swap_b32 v184, v186
    v_permlane32_swap_b32 v185, v187
    buffer_store_dwordx4 v[184:187], v224, s[84:87], s70 offen offset:0
    v_cvt_pk_bf16_f32 v192, v192, v193
    v_cvt_pk_bf16_f32 v193, v194, v195
    v_cvt_pk_bf16_f32 v194, v196, v197
    v_cvt_pk_bf16_f32 v195, v198, v199
    s_nop 0
    v_permlane32_swap_b32 v192, v194
    v_permlane32_swap_b32 v193, v195
    buffer_store_dwordx4 v[192:195], v224, s[84:87], s70 offen offset:64
    s_cmp_eq_u32 s64, 6
    s_cbranch_scc1 dn_skip
    v_cvt_pk_bf16_f32 v200, v200, v201
    v_cvt_pk_bf16_f32 v201, v202, v203
    v_cvt_pk_bf16_f32 v202, v204, v205
    v_cvt_pk_bf16_f32 v203, v206, v207
    s_nop 0
    v_permlane32_swap_b32 v200, v202
    v_permlane32_swap_b32 v201, v203
    buffer_store_dwordx4 v[200:203], v224, s[84:87], s70 offen offset:128
dn_skip:
main_end:
    s_endpgm
code_end:
.section .rodata,"a"
.p2align 6
.amdhsa_kernel qkv_kernel
  .amdhsa_next_free_vgpr 128
  .amdhsa_next_free_sgpr 102
  .amdhsa_accum_offset 128
  .amdhsa_group_segment_fixed_size 0
  .amdhsa_kernarg_size 96
  .amdhsa_user_sgpr_count 2
  .amdhsa_user_sgpr_kernarg_segment_ptr 1
  .amdhsa_system_sgpr_workgroup_id_x 1
.end_amdhsa_kernel
.p2align 6
.amdhsa_kernel main_kernel
  .amdhsa_next_free_vgpr 248
  .amdhsa_next_free_sgpr 102
  .amdhsa_accum_offset 248
  .amdhsa_group_segment_fixed_size 0
  .amdhsa_kernarg_size 96
  .amdhsa_user_sgpr_count 2
  .amdhsa_user_sgpr_kernarg_segment_ptr 1
  .amdhsa_system_sgpr_workgroup_id_x 1
.end_amdhsa_kernel
```
